```python
import torch

def _softmax(x, axis=-1):
    return torch.softmax(x, dim=axis)
def _gelu(x):
    return torch.nn.functional.gelu(x, approximate="tanh")
def _silu(x):
    return torch.nn.functional.silu(x)
def _sigmoid(x):
    return torch.sigmoid(x)
def _layernorm(x, axis=-1, eps=1e-5):
    m = x.mean(dim=axis, keepdim=True)
    v = x.var(dim=axis, keepdim=True, unbiased=False)
    return (x - m) / torch.sqrt(v + eps)
def _scatter_add(tgt, idx, src, axis=0):
    return tgt.clone().index_add_(axis, idx, src)
def _segment_sum(src, seg, n):
    out = torch.zeros((n,) + src.shape[1:], dtype=src.dtype)
    return out.index_add_(0, seg, src)
def _pad(x, pw):
    flat = tuple(v for pair in reversed(pw) for v in pair)
    return torch.nn.functional.pad(x, flat)

kernel_name = 'recurrent_scan__ssm_conv_s4__moe_arch_mod__prompt'

def setup_inputs():

    _w = (lambda a: (lambda t: t.to(torch.bfloat16) if t.is_floating_point() else t)(torch.as_tensor(a)))
    def _A_setup():
        B, L, D, N = 1, 2048, 512, 128
        A_re = -(lambda _x: torch.exp(torch.as_tensor(_x)))((lambda *s: torch.randn(*s, dtype=torch.bfloat16) * 6.4)(D, N))
        A_im = torch.pi * (lambda *s: torch.randn(*s, dtype=torch.bfloat16) * 0.05)(D, N)
        B_re = (lambda *s: torch.randn(*s, dtype=torch.bfloat16) * 0.1)(D, N)
        B_im = (lambda *s: torch.randn(*s, dtype=torch.bfloat16) * 0.1)(D, N)
        C_re = (lambda *s: torch.randn(*s, dtype=torch.bfloat16) * 0.1)(D, N)
        C_im = (lambda *s: torch.randn(*s, dtype=torch.bfloat16) * 0.1)(D, N)
        log_dt = (lambda *s: torch.randn(*s, dtype=torch.bfloat16) * 0.05)(D) * 0.5 - 4.0
        Dskip = (lambda *s: torch.randn(*s, dtype=torch.bfloat16) * 0.05)(D)
        return {
            "u": _w((lambda *s: torch.randn(*s, dtype=torch.bfloat16) * 0.05)(B, L, D)),
            "A_re": _w(A_re),
            "A_im": _w(A_im),
            "B_re": _w(B_re),
            "B_im": _w(B_im),
            "C_re": _w(C_re),
            "C_im": _w(C_im),
            "log_dt": _w(log_dt),
            "Dskip": _w(Dskip),
        }
    _A_in = _A_setup()

    def _B_setup():
        B, S, D, F, C = 1, 2048, 512, 1792, 2
        return {
            "x": _w((lambda *s: torch.randn(*s, dtype=torch.bfloat16) * 0.05)(B, S, D)),
            "w_r": _w((lambda *s: torch.randn(*s, dtype=torch.bfloat16) * 3.2)(D)),
            "w_gate": _w((lambda *s: torch.randn(*s, dtype=torch.bfloat16) * 0.05)(D, F)),
            "w_up": _w((lambda *s: torch.randn(*s, dtype=torch.bfloat16) * 0.05)(D, F)),
            "w_down": _w((lambda *s: torch.randn(*s, dtype=torch.bfloat16) * 0.05)(F, D)),
        }
    _B_in = _B_setup()

    return {
        "A_u": _A_in["u"],
        "A_A_re": _A_in["A_re"],
        "A_A_im": _A_in["A_im"],
        "A_B_re": _A_in["B_re"],
        "A_B_im": _A_in["B_im"],
        "A_C_re": _A_in["C_re"],
        "A_C_im": _A_in["C_im"],
        "A_log_dt": _A_in["log_dt"],
        "A_Dskip": _A_in["Dskip"],
        "B_x": _B_in["x"],
        "B_w_r": _B_in["w_r"],
        "B_w_gate": _B_in["w_gate"],
        "B_w_up": _B_in["w_up"],
        "B_w_down": _B_in["w_down"],
    }

def reference(A_u, A_A_re, A_A_im, A_B_re, A_B_im, A_C_re, A_C_im, A_log_dt, A_Dskip, B_x, B_w_r, B_w_gate, B_w_up, B_w_down):
    def _A_ref(u, A_re, A_im, B_re, B_im, C_re, C_im, log_dt, Dskip):
        Bsz, L, D = u.shape
        dt = torch.exp(log_dt)[:, None]
        A = A_re + 1j * A_im
        Bc = B_re + 1j * B_im
        Cc = C_re + 1j * C_im
        logdA = dt * A
        dB = dt * Bc
        l = (lambda x, dt: x.to(dt))(torch.arange(L), A_re.dtype)
        P = torch.exp(logdA[:, :, None] * l[None, None, :])
        K = torch.einsum("dn,dnl,dn->dl", Cc, P, dB).real
        L2 = 2 * L
        Kp = _pad(K, ((0, 0), (0, L)))
        up = (lambda x, *d: x.permute(*d))(u, 0, 2, 1)
        up = _pad(up, ((0, 0), (0, 0), (0, L)))
        Kf = (lambda x, axes=(-2,-1): torch.fft.rfft2(x.float(), dim=axes))(Kp[:, None, :], axes=(-2, -1))
        Uf = (lambda x, axes=(-2,-1): torch.fft.rfft2(x.float(), dim=axes))(up[:, :, None, :], axes=(-2, -1))
        Yf = Uf * Kf[None, :, :, :]
        y = (lambda x, s, axes=(-2,-1): torch.fft.irfft2(x, s=s, dim=axes).to(torch.bfloat16))(Yf, (1, L2), axes=(-2, -1))[:, :, 0, :L]
        y = (lambda x, *d: x.permute(*d))(y, 0, 2, 1) + u * Dskip[None, None, :]
        return y

    def _B_ref(x, w_r, w_gate, w_up, w_down):
        B, S, D = x.shape
        C = 2
        r = x @ w_r
        idx = torch.argsort(-r, axis=-1)[:, :C]
        idx_e = (lambda x, n, axis: torch.repeat_interleave(x, n, dim=axis))(idx.reshape(B, C, 1), D, axis=2)
        x_sel = (lambda x, i, axis: torch.take_along_dim(x, i, dim=axis))(x, idx_e, axis=1)
        g = _silu(x_sel @ w_gate)
        u = x_sel @ w_up
        y = (g * u) @ w_down
        r_sel = _sigmoid((lambda x, i, axis: torch.take_along_dim(x, i, dim=axis))(r, idx, axis=1))
        y = y * r_sel.reshape(B, C, 1)
        b_off = (torch.arange(B) * S).reshape(B, 1)
        flat_idx = (idx + b_off).reshape(B * C)
        zero = (x * 0.0).reshape(B * S, D)
        upd = _scatter_add(zero, flat_idx, y.reshape(B * C, D), axis=0)
        return x + upd.reshape(B, S, D)

    x = A_u
    xn = _layernorm(x, axis=-1)
    s = _A_ref(xn, A_A_re, A_A_im, A_B_re, A_B_im, A_C_re, A_C_im, A_log_dt, A_Dskip)
    g = _silu(_B_ref(xn, B_w_r, B_w_gate, B_w_up, B_w_down))
    return x + s * g
```

```asm
; @launch grid=(256,1,1) block=(512,1,1) lds=139008
.amdgcn_target "amdgcn-amd-amdhsa--gfx950"
.text
.globl recurrent_scan__ssm_conv_s4__moe_arch_mod__prompt_kernel
.p2align 8
.type recurrent_scan__ssm_conv_s4__moe_arch_mod__prompt_kernel,@function
recurrent_scan__ssm_conv_s4__moe_arch_mod__prompt_kernel:
    s_cmp_ge_u32 s2, 256
    s_cbranch_scc1 L_end
    s_load_dwordx16 s[8:23], s[0:1], 0
    s_load_dwordx16 s[24:39], s[0:1], 64
    s_load_dwordx2 s[40:41], s[0:1], 128
    v_lshrrev_b32 v2, 6, v0
    v_and_b32_e64 v1, 63, v0
    v_readfirstlane_b32 s3, v2
    s_and_b32 s6, s2, 7
    s_bfe_u32 s5, s2, 0x40003
    s_lshl4_add_u32 s4, s6, s5
    s_cmp_lt_u32 s2, 128
    s_cbranch_scc1 L_aux0
    s_and_b32 s43, s3, 3
    s_lshr_b32 s74, s3, 2
    s_lshl2_add_u32 s71, s4, s43
    s_lshl1_add_u32 s71, s71, s74
    s_lshl_b32 s71, s71, 7
    v_lshl_add_u32 v2, v1, 1, s71
    v_mov_b64 v[10:11], 0
    v_mov_b64 v[12:13], 0
    v_mov_b64 v[14:15], 0
    s_lshl_b32 s7, s4, 3
    s_waitcnt lgkmcnt(0)
    global_load_short_d16_hi v10, v2, s[10:11]
    global_load_short_d16_hi v11, v2, s[12:13]
    global_load_short_d16_hi v12, v2, s[14:15]
    global_load_short_d16_hi v13, v2, s[16:17]
    global_load_short_d16_hi v14, v2, s[18:19]
    global_load_short_d16_hi v15, v2, s[20:21]
    s_load_dwordx2 s[58:59], s[22:23], s7
    s_branch L_conv
L_aux0:
    s_and_b32 s7, s2, 0x78
    s_getpc_b64 s[56:57]
L_pc0:
    v_add_lshl_u32 v254, v2, s7, 7
    v_min_u32 v254, L_code_end-L_pc0-4, v254
    global_load_dword v255, v254, s[56:57]
    s_cmp_ge_u32 s3, 4
    s_cbranch_scc1 L_aux_loader
    v_lshlrev_b32 v3, 4, v0
    v_lshlrev_b32 v2, 6, v0
    v_and_b32 v3, 0xf0, v3
    s_lshl_b32 s7, s4, 14
    v_and_b32 v2, 0x3c00, v2
    v_or3_b32 v2, v2, v3, s7
    s_waitcnt lgkmcnt(0)
    global_load_dwordx4 v[24:27], v3, s[28:29] offset:0
    global_load_dwordx4 v[28:31], v3, s[28:29] offset:256
    global_load_dwordx4 v[32:35], v3, s[28:29] offset:512
    global_load_dwordx4 v[36:39], v3, s[28:29] offset:768
    global_load_dwordx4 v[8:11], v2, s[8:9] offset:0
    global_load_dwordx4 v[12:15], v2, s[8:9] offset:256
    global_load_dwordx4 v[16:19], v2, s[8:9] offset:512
    global_load_dwordx4 v[20:23], v2, s[8:9] offset:768
    s_load_dword s42, s[40:41], 0
    v_mov_b64 v[40:41], 0
    v_mov_b64 v[42:43], 0
    s_lshl_b32 s7, s4, 7
    v_lshrrev_b32 v4, 1, v0
    v_add_u32_e64 v48, s7, v4
    v_add_u32 v48, 4096, v48
    s_lshl_b32 s7, s4, 12
    s_add_u32 s7, s7, 65536
    v_lshlrev_b32 v2, 4, v0
    v_add_u32_e64 v5, s7, v2
    global_store_dwordx4 v5, v[40:43], s[40:41] sc1
    s_branch L_aux
L_conv:
    s_load_dwordx2 s[60:61], s[24:25], s7
    s_load_dword s42, s[40:41], 0
    s_lshl_b32 s73, s5, 17
    s_lshl_b32 s72, s3, 14
    s_add_u32 s73, s73, s72
    s_add_u32 s73, s73, s7
    v_and_b32 v20, 15, v1
    v_lshl_add_u32 v3, v20, 10, s73
    v_and_b32 v4, 255, v0
    v_lshl_add_u32 v240, v4, 11, s7
    s_xor_b32 s74, s74, 1
    s_lshl_b32 s73, s74, 19
    v_add_u32_e64 v253, s73, v240
    v_add_u32 v254, 0x100000, v253
    s_lshl_b32 s73, s74, 12
    v_lshl_add_u32 v252, v4, 4, s73
    s_cmp_ge_u32 s3, 4
    s_cselect_b32 s72, s40, s36
    s_cselect_b32 s73, s41, s37
    v_mov_b32 v4, 2048
    global_load_dword v255, v3, s[8:9]
    global_load_dword v255, v4, s[72:73]
    s_cmp_ge_u32 s3, 4
    s_cbranch_scc1 L_b0
    v_mov_b32 v16, 0
    v_mov_b32 v17, 0
    v_mov_b32 v18, 0
    v_mov_b32 v19, 0
    s_mul_i32 s73, s43, 4608
    v_lshl_add_u32 v22, v1, 3, s73
    ds_write_b64 v22, v[16:17] offset:0
    s_mul_i32 s72, s43, 6464
    s_add_u32 s72, s72, 80384
    v_lshl_add_u32 v22, v1, 4, s72
    ds_write_b128 v22, v[16:19] offset:5376
    v_lshrrev_b32_e64 v21, 4, v1
    v_mul_u32_u24 v22, 1344, v21
    v_lshl_add_u32 v22, v20, 4, v22
    v_cmp_lt_u32 vcc, 2, v20
    v_mov_b32 v23, 1008
    s_nop 0
    v_cndmask_b32 v23, 0, v23, vcc
    v_add3_u32 v22, v22, v23, s72
    ds_write_b128 v22, v[16:19]
    v_lshrrev_b32 v21, 4, v1
    v_bfe_u32 v24, v1, 2, 2
    v_mul_u32_u24 v24, 1344, v24
    v_and_b32_e64 v25, 3, v1
    v_lshl_add_u32 v24, v25, 3, v24
    v_and_b32 v25, 48, v1
    v_sub_u32 v24, v24, v25
    s_add_u32 s73, s72, 48
    v_add_u32 v196, s73, v24
    v_lshlrev_b32 v26, 2, v21
    v_sub_u32 v26, v26, v20
    s_add_u32 s73, s72, 5436
    v_lshl_add_u32 v197, v26, 2, s73
    v_lshrrev_b32 v26, 1, v21
    v_and_b32 v27, 1, v21
    v_lshlrev_b32_e64 v28, 8, v26
    v_lshl_add_u32 v28, v27, 3, v28
    v_lshl_add_u32 v28, v20, 4, v28
    s_add_u32 s73, s72, 32
    v_add_u32 v198, s73, v28
    v_lshlrev_b32_e64 v28, 8, v21
    v_lshl_add_u32 v28, v20, 4, v28
    s_add_u32 s73, s72, 528
    v_add_u32_e64 v199, s73, v28
    v_add_u32 v200, 4032, v199
    v_add_u32 v201, 2688, v199
    v_lshlrev_b32 v28, 6, v27
    v_and_b32 v29, 1, v20
    v_lshlrev_b32 v29, 8, v29
    v_and_b32 v30, 14, v20
    v_lshl_add_u32 v30, v30, 1, v28
    v_sub_u32_e64 v30, v29, v30
    s_add_u32 s73, s72, 5532
    v_add_u32 v202, s73, v30
    v_add_u32 v30, 1, v20
    v_and_b32_e64 v30, 30, v30
    v_lshl_add_u32 v30, v30, 1, v28
    v_add_u32_e64 v30, v29, v30
    s_add_u32 s73, s72, 5794
    v_sub_u32 v203, s73, v30
    v_add_u32 v204, 32, v203
    s_add_u32 s73, s72, 6400
    v_writelane_b32 v204, s73, 32
    v_add_u32 v30, 1, v20
    v_and_b32 v31, 1, v30
    v_and_b32 v30, 30, v30
    v_sub_u32 v30, v31, v30
    v_lshlrev_b32 v31, 7, v21
    v_lshlrev_b32 v30, 1, v30
    v_sub_u32_e64 v30, v30, v31
    s_add_u32 s73, s72, 6048
    v_add_u32_e64 v205, s73, v30
    v_add_u32 v206, 96, v205
    s_add_u32 s73, s72, 5698
    v_writelane_b32 v206, s73, 0
    v_mov_b32_e64 v207, 0
    s_mov_b32 s74, 0x3ef5fdf0
    v_writelane_b32 v207, s74, 0
L_b0:
    s_barrier
    global_load_dwordx2 v[244:245], v253, s[8:9] offset:0
    global_load_dwordx2 v[246:247], v253, s[8:9] offset:1024
    v_add_u32 v238, 8192, v252
    v_add_u32 v239, 8192, v238
    s_cmp_ge_u32 s3, 4
    s_cbranch_scc1 L_touch_row
    v_lshrrev_b32 v22, 1, v1
    v_and_b32 v22, 24, v22
    v_sub_u32_e64 v22, v20, v22
    s_lshl_b32 s7, s43, 2
    s_lshr_b32 s71, 0x7961, s7
    s_and_b32 s71, s71, 15
    s_sub_u32 s71, s71, 4
    s_lshr_b32 s72, 0x7353, s7
    s_and_b32 s72, s72, 15
    s_bfm_b32 s72, s72, 8
    s_movk_i32 s73, 0x3f80
    s_mov_b32 s74, 0x10001
    s_lshl_b32 s7, s43, 12
    s_and_b32 s7, s7, 0x2000
    s_add_u32 s7, s7, 112384
    v_lshl_add_u32 v21, v1, 4, s7
    s_and_b32 s75, s43, 1
    s_lshl_b32 s75, s75, 10
    v_add_u32 v21, s75, v21
    v_sub_u32 v23, s71, v22
    v_med3_i32 v23, v23, 0, 31
    v_lshrrev_b32 v23, v23, s72
    v_bfe_u32 v28, v23, 0, 2
    v_mul_u32_u24 v28, 0x8001, v28
    v_and_b32 v28, s74, v28
    v_mul_u32_u24 v24, s73, v28
    v_bfe_u32 v28, v23, 2, 2
    v_mul_u32_u24 v28, 0x8001, v28
    v_and_b32 v28, s74, v28
    v_mul_u32_u24 v25, s73, v28
    v_bfe_u32 v28, v23, 4, 2
    v_mul_u32_u24 v28, 0x8001, v28
    v_and_b32 v28, s74, v28
    v_mul_u32_u24 v26, s73, v28
    v_bfe_u32 v28, v23, 6, 2
    v_mul_u32_u24 v28, 0x8001, v28
    v_and_b32 v28, s74, v28
    v_mul_u32_u24 v27, s73, v28
    ds_write_b128 v21, v[24:27]
    s_cmp_lg_u32 s75, 0
    s_cselect_b32 s71, -4, 4
    s_cselect_b32 s72, 2, 9
    s_cselect_b32 s73, 0xffff, s73
    s_bfm_b32 s72, s72, 8
    s_add_u32 s75, s75, 128768
    v_lshl_add_u32 v21, v1, 4, s75
    v_sub_u32_e64 v23, s71, v22
    v_med3_i32 v23, v23, 0, 31
    v_lshrrev_b32 v23, v23, s72
    v_bfe_u32 v28, v23, 0, 2
    v_mul_u32_u24 v28, 0x8001, v28
    v_and_b32 v28, s74, v28
    v_mul_u32_u24 v24, s73, v28
    v_bfe_u32 v28, v23, 2, 2
    v_mul_u32_u24 v28, 0x8001, v28
    v_and_b32 v28, s74, v28
    v_mul_u32_u24 v25, s73, v28
    v_bfe_u32 v28, v23, 4, 2
    v_mul_u32_u24 v28, 0x8001, v28
    v_and_b32 v28, s74, v28
    v_mul_u32_u24 v26, s73, v28
    v_bfe_u32 v28, v23, 6, 2
    v_mul_u32_u24 v28, 0x8001, v28
    v_and_b32 v28, s74, v28
    v_mul_u32_u24 v27, s73, v28
    ds_write_b128 v21, v[24:27]
L_consts_done:
    v_mul_u32_u24 v2, 2080, v20
    s_lshl_b32 m0, s3, 8
    v_and_b32 v3, 48, v1
    v_add3_u32 v2, v2, v3, m0
    s_mul_i32 s7, s43, 3072
    s_add_u32 s7, s7, 68096
    v_lshl_add_u32 v3, v1, 4, s7
    s_lshl_b32 s7, s43, 4
    v_mov_b32 v16, 0x3fb8aa3b
    s_waitcnt lgkmcnt(0)
    s_lshr_b64 s[58:59], s[58:59], s7
    s_lshr_b64 s[60:61], s[60:61], s7
    s_lshl_b32 s58, s58, 16
    s_lshl_b32 s60, s60, 16
    v_mul_f32 v17, s58, v16
    v_exp_f32_e64 v17, v17
    s_or_b32 s42, s42, 1
    s_add_u32 s42, s42, 0x9e3779b8
    v_cvt_pk_bf16_f32 v17, v17, v17
    v_and_b32 v17, 0xffff0000, v17
    v_mul_f32 v18, v17, v16
    v_mul_f32 v19, 0.15915494, v17
    v_mul_f32 v17, 0x3ef5fdf0, v17
    s_cmp_ge_u32 s3, 4
    s_waitcnt vmcnt(8)
    v_mul_f32 v10, v10, v18
    v_mul_f32 v11, v11, v19
    v_mul_f32 v4, 0x41000000, v10
    v_mul_f32 v5, 0x41000000, v11
    v_exp_f32 v4, v4
    v_fract_f32 v5, v5
    v_cos_f32 v22, v5
    v_sin_f32_e64 v23, v5
    s_nop 0
    v_pk_mul_f32 v[22:23], v[22:23], v[4:5] op_sel:[0,0] op_sel_hi:[1,0] neg_hi:[1,0]
    v_mov_b32 v44, 0x3f80
    ds_write_addtid_b32 v44 offset:18432
    v_cvt_pk_bf16_f32 v45, v22, v23
    ds_write_addtid_b32 v45 offset:20512
    v_pk_mul_f32 v[40:41], v[22:23], v[22:23] op_sel:[0,0] op_sel_hi:[1,0]
    v_pk_fma_f32 v[40:41], v[22:23], v[22:23], v[40:41] op_sel:[1,1,0] op_sel_hi:[0,1,1] neg_lo:[0,1,0]
    v_cvt_pk_bf16_f32 v46, v40, v41
    ds_write_addtid_b32 v46 offset:22592
    v_pk_mul_f32 v[42:43], v[40:41], v[22:23] op_sel:[0,0] op_sel_hi:[1,0]
    v_pk_fma_f32 v[42:43], v[40:41], v[22:23], v[42:43] op_sel:[1,1,0] op_sel_hi:[0,1,1] neg_lo:[0,1,0]
    v_cvt_pk_bf16_f32 v47, v42, v43
    ds_write_addtid_b32 v47 offset:24672
    v_pk_mul_f32 v[40:41], v[42:43], v[22:23] op_sel:[0,0] op_sel_hi:[1,0]
    v_pk_fma_f32 v[40:41], v[42:43], v[22:23], v[40:41] op_sel:[1,1,0] op_sel_hi:[0,1,1] neg_lo:[0,1,0]
    v_cvt_pk_bf16_f32 v44, v40, v41
    ds_write_addtid_b32 v44 offset:26752
    v_pk_mul_f32 v[42:43], v[40:41], v[22:23] op_sel:[0,0] op_sel_hi:[1,0]
    v_pk_fma_f32 v[42:43], v[40:41], v[22:23], v[42:43] op_sel:[1,1,0] op_sel_hi:[0,1,1] neg_lo:[0,1,0]
    v_cvt_pk_bf16_f32 v45, v42, v43
    ds_write_addtid_b32 v45 offset:28832
    v_pk_mul_f32 v[40:41], v[42:43], v[22:23] op_sel:[0,0] op_sel_hi:[1,0]
    v_pk_fma_f32 v[40:41], v[42:43], v[22:23], v[40:41] op_sel:[1,1,0] op_sel_hi:[0,1,1] neg_lo:[0,1,0]
    v_cvt_pk_bf16_f32 v46, v40, v41
    ds_write_addtid_b32 v46 offset:30912
    v_pk_mul_f32 v[42:43], v[40:41], v[22:23] op_sel:[0,0] op_sel_hi:[1,0]
    v_pk_fma_f32 v[42:43], v[40:41], v[22:23], v[42:43] op_sel:[1,1,0] op_sel_hi:[0,1,1] neg_lo:[0,1,0]
    v_cvt_pk_bf16_f32 v47, v42, v43
    ds_write_addtid_b32 v47 offset:32992
    v_pk_mul_f32 v[40:41], v[42:43], v[22:23] op_sel:[0,0] op_sel_hi:[1,0]
    v_pk_fma_f32 v[40:41], v[42:43], v[22:23], v[40:41] op_sel:[1,1,0] op_sel_hi:[0,1,1] neg_lo:[0,1,0]
    v_cvt_pk_bf16_f32 v44, v40, v41
    ds_write_addtid_b32 v44 offset:35072
    v_pk_mul_f32 v[42:43], v[40:41], v[22:23] op_sel:[0,0] op_sel_hi:[1,0]
    v_pk_fma_f32 v[42:43], v[40:41], v[22:23], v[42:43] op_sel:[1,1,0] op_sel_hi:[0,1,1] neg_lo:[0,1,0]
    v_cvt_pk_bf16_f32 v45, v42, v43
    ds_write_addtid_b32 v45 offset:37152
    v_pk_mul_f32 v[40:41], v[42:43], v[22:23] op_sel:[0,0] op_sel_hi:[1,0]
    v_pk_fma_f32 v[40:41], v[42:43], v[22:23], v[40:41] op_sel:[1,1,0] op_sel_hi:[0,1,1] neg_lo:[0,1,0]
    v_cvt_pk_bf16_f32 v46, v40, v41
    ds_write_addtid_b32 v46 offset:39232
    v_pk_mul_f32 v[42:43], v[40:41], v[22:23] op_sel:[0,0] op_sel_hi:[1,0]
    v_pk_fma_f32 v[42:43], v[40:41], v[22:23], v[42:43] op_sel:[1,1,0] op_sel_hi:[0,1,1] neg_lo:[0,1,0]
    v_cvt_pk_bf16_f32 v47, v42, v43
    ds_write_addtid_b32 v47 offset:41312
    v_pk_mul_f32 v[40:41], v[42:43], v[22:23] op_sel:[0,0] op_sel_hi:[1,0]
    v_pk_fma_f32 v[40:41], v[42:43], v[22:23], v[40:41] op_sel:[1,1,0] op_sel_hi:[0,1,1] neg_lo:[0,1,0]
    v_cvt_pk_bf16_f32 v44, v40, v41
    ds_write_addtid_b32 v44 offset:43392
    v_pk_mul_f32 v[42:43], v[40:41], v[22:23] op_sel:[0,0] op_sel_hi:[1,0]
    v_pk_fma_f32 v[42:43], v[40:41], v[22:23], v[42:43] op_sel:[1,1,0] op_sel_hi:[0,1,1] neg_lo:[0,1,0]
    v_cvt_pk_bf16_f32 v45, v42, v43
    ds_write_addtid_b32 v45 offset:45472
    v_pk_mul_f32 v[40:41], v[42:43], v[22:23] op_sel:[0,0] op_sel_hi:[1,0]
    v_pk_fma_f32 v[40:41], v[42:43], v[22:23], v[40:41] op_sel:[1,1,0] op_sel_hi:[0,1,1] neg_lo:[0,1,0]
    v_cvt_pk_bf16_f32 v46, v40, v41
    ds_write_addtid_b32 v46 offset:47552
    v_pk_mul_f32 v[42:43], v[40:41], v[22:23] op_sel:[0,0] op_sel_hi:[1,0]
    v_pk_fma_f32 v[42:43], v[40:41], v[22:23], v[42:43] op_sel:[1,1,0] op_sel_hi:[0,1,1] neg_lo:[0,1,0]
    v_cvt_pk_bf16_f32 v47, v42, v43
    ds_write_addtid_b32 v47 offset:49632
    ds_read_b128 v[48:51], v2 offset:18432
    ds_read_b128 v[52:55], v2 offset:18496
    ds_read_b128 v[56:59], v2 offset:18560
    ds_read_b128 v[60:63], v2 offset:18624
    v_exp_f32 v4, v10
    v_fract_f32 v5, v11
    v_cos_f32 v20, v5
    v_sin_f32_e64 v21, v5
    s_nop 0
    v_pk_mul_f32 v[20:21], v[20:21], v[4:5] op_sel:[0,0] op_sel_hi:[1,0]
    v_mul_f32 v4, 0x43000000, v10
    v_mul_f32 v5, 0x43000000, v11
    v_exp_f32 v4, v4
    v_fract_f32 v5, v5
    v_cos_f32 v24, v5
    v_sin_f32_e64 v25, v5
    s_nop 0
    v_pk_mul_f32 v[24:25], v[24:25], v[4:5] op_sel:[0,0] op_sel_hi:[1,0]
    s_waitcnt vmcnt(4)
    s_nop 0
    v_pk_mul_f32 v[12:13], v[12:13], v[16:17] op_sel:[0,1] op_sel_hi:[1,1]
    v_pk_mul_f32 v[36:37], v[14:15], v[12:13] op_sel:[0,0] op_sel_hi:[1,0]
    v_pk_fma_f32 v[36:37], v[14:15], v[12:13], v[36:37] op_sel:[1,1,0] op_sel_hi:[0,1,1] neg_lo:[0,1,0]
    v_cvt_pk_bf16_f32 v44, v36, v37
    ds_write_addtid_b32 v44 offset:18432
    v_pk_mul_f32 v[40:41], v[36:37], v[20:21] op_sel:[0,0] op_sel_hi:[1,0]
    v_pk_fma_f32 v[40:41], v[36:37], v[20:21], v[40:41] op_sel:[1,1,0] op_sel_hi:[0,1,1] neg_lo:[0,1,0]
    v_cvt_pk_bf16_f32 v45, v40, v41
    ds_write_addtid_b32 v45 offset:20512
    s_cbranch_scc1 L_me0
    s_nop 0
    global_load_dwordx2 v[248:249], v254, s[8:9] offset:0
L_me0:
    v_pk_mul_f32 v[42:43], v[40:41], v[20:21] op_sel:[0,0] op_sel_hi:[1,0]
    v_pk_fma_f32 v[42:43], v[40:41], v[20:21], v[42:43] op_sel:[1,1,0] op_sel_hi:[0,1,1] neg_lo:[0,1,0]
    v_cvt_pk_bf16_f32 v46, v42, v43
    ds_write_addtid_b32 v46 offset:22592
    v_pk_mul_f32 v[40:41], v[42:43], v[20:21] op_sel:[0,0] op_sel_hi:[1,0]
    v_pk_fma_f32 v[40:41], v[42:43], v[20:21], v[40:41] op_sel:[1,1,0] op_sel_hi:[0,1,1] neg_lo:[0,1,0]
    v_cvt_pk_bf16_f32 v47, v40, v41
    ds_write_addtid_b32 v47 offset:24672
    v_pk_mul_f32 v[42:43], v[40:41], v[20:21] op_sel:[0,0] op_sel_hi:[1,0]
    v_pk_fma_f32 v[42:43], v[40:41], v[20:21], v[42:43] op_sel:[1,1,0] op_sel_hi:[0,1,1] neg_lo:[0,1,0]
    v_cvt_pk_bf16_f32 v44, v42, v43
    ds_write_addtid_b32 v44 offset:26752
    v_pk_mul_f32 v[40:41], v[42:43], v[20:21] op_sel:[0,0] op_sel_hi:[1,0]
    v_pk_fma_f32 v[40:41], v[42:43], v[20:21], v[40:41] op_sel:[1,1,0] op_sel_hi:[0,1,1] neg_lo:[0,1,0]
    v_cvt_pk_bf16_f32 v45, v40, v41
    ds_write_addtid_b32 v45 offset:28832
    v_pk_mul_f32 v[42:43], v[40:41], v[20:21] op_sel:[0,0] op_sel_hi:[1,0]
    v_pk_fma_f32 v[42:43], v[40:41], v[20:21], v[42:43] op_sel:[1,1,0] op_sel_hi:[0,1,1] neg_lo:[0,1,0]
    v_cvt_pk_bf16_f32 v46, v42, v43
    ds_write_addtid_b32 v46 offset:30912
    v_pk_mul_f32 v[40:41], v[42:43], v[20:21] op_sel:[0,0] op_sel_hi:[1,0]
    v_pk_fma_f32 v[40:41], v[42:43], v[20:21], v[40:41] op_sel:[1,1,0] op_sel_hi:[0,1,1] neg_lo:[0,1,0]
    v_cvt_pk_bf16_f32 v47, v40, v41
    ds_write_addtid_b32 v47 offset:32992
    v_pk_mul_f32 v[38:39], v[36:37], v[24:25] op_sel:[0,0] op_sel_hi:[1,0]
    v_pk_fma_f32 v[38:39], v[36:37], v[24:25], v[38:39] op_sel:[1,1,0] op_sel_hi:[0,1,1] neg_lo:[0,1,0]
    v_cvt_pk_bf16_f32 v44, v38, v39
    ds_write_addtid_b32 v44 offset:35072
    v_pk_mul_f32 v[40:41], v[38:39], v[20:21] op_sel:[0,0] op_sel_hi:[1,0]
    v_pk_fma_f32 v[40:41], v[38:39], v[20:21], v[40:41] op_sel:[1,1,0] op_sel_hi:[0,1,1] neg_lo:[0,1,0]
    v_cvt_pk_bf16_f32 v45, v40, v41
    ds_write_addtid_b32 v45 offset:37152
    s_cbranch_scc1 L_me1
    s_nop 0
    global_load_dwordx2 v[250:251], v254, s[8:9] offset:1024
L_me1:
    v_pk_mul_f32 v[42:43], v[40:41], v[20:21] op_sel:[0,0] op_sel_hi:[1,0]
    v_pk_fma_f32 v[42:43], v[40:41], v[20:21], v[42:43] op_sel:[1,1,0] op_sel_hi:[0,1,1] neg_lo:[0,1,0]
    v_cvt_pk_bf16_f32 v46, v42, v43
    ds_write_addtid_b32 v46 offset:39232
    v_pk_mul_f32 v[40:41], v[42:43], v[20:21] op_sel:[0,0] op_sel_hi:[1,0]
    v_pk_fma_f32 v[40:41], v[42:43], v[20:21], v[40:41] op_sel:[1,1,0] op_sel_hi:[0,1,1] neg_lo:[0,1,0]
    v_cvt_pk_bf16_f32 v47, v40, v41
    ds_write_addtid_b32 v47 offset:41312
    v_pk_mul_f32 v[42:43], v[40:41], v[20:21] op_sel:[0,0] op_sel_hi:[1,0]
    v_pk_fma_f32 v[42:43], v[40:41], v[20:21], v[42:43] op_sel:[1,1,0] op_sel_hi:[0,1,1] neg_lo:[0,1,0]
    v_cvt_pk_bf16_f32 v44, v42, v43
    ds_write_addtid_b32 v44 offset:43392
    v_pk_mul_f32 v[40:41], v[42:43], v[20:21] op_sel:[0,0] op_sel_hi:[1,0]
    v_pk_fma_f32 v[40:41], v[42:43], v[20:21], v[40:41] op_sel:[1,1,0] op_sel_hi:[0,1,1] neg_lo:[0,1,0]
    v_cvt_pk_bf16_f32 v45, v40, v41
    ds_write_addtid_b32 v45 offset:45472
    v_pk_mul_f32 v[42:43], v[40:41], v[20:21] op_sel:[0,0] op_sel_hi:[1,0]
    v_pk_fma_f32 v[42:43], v[40:41], v[20:21], v[42:43] op_sel:[1,1,0] op_sel_hi:[0,1,1] neg_lo:[0,1,0]
    v_cvt_pk_bf16_f32 v46, v42, v43
    ds_write_addtid_b32 v46 offset:47552
    v_pk_mul_f32 v[40:41], v[42:43], v[20:21] op_sel:[0,0] op_sel_hi:[1,0]
    v_pk_fma_f32 v[40:41], v[42:43], v[20:21], v[40:41] op_sel:[1,1,0] op_sel_hi:[0,1,1] neg_lo:[0,1,0]
    v_cvt_pk_bf16_f32 v47, v40, v41
    ds_write_addtid_b32 v47 offset:49632
    ds_read_b128 v[64:67], v2 offset:18432
    ds_read_b128 v[68:71], v2 offset:18496
    ds_read_b128 v[72:75], v2 offset:18560
    ds_read_b128 v[76:79], v2 offset:18624
    v_pk_mul_f32 v[26:27], v[20:21], v[20:21] op_sel:[0,0] op_sel_hi:[1,0]
    v_pk_fma_f32 v[26:27], v[20:21], v[20:21], v[26:27] op_sel:[1,1,0] op_sel_hi:[0,1,1] neg_lo:[0,1,0]
    v_pk_mul_f32 v[28:29], v[26:27], v[26:27] op_sel:[0,0] op_sel_hi:[1,0]
    v_pk_fma_f32 v[28:29], v[26:27], v[26:27], v[28:29] op_sel:[1,1,0] op_sel_hi:[0,1,1] neg_lo:[0,1,0]
    v_pk_mul_f32 v[36:37], v[38:39], v[24:25] op_sel:[0,0] op_sel_hi:[1,0]
    v_pk_fma_f32 v[36:37], v[38:39], v[24:25], v[36:37] op_sel:[1,1,0] op_sel_hi:[0,1,1] neg_lo:[0,1,0]
    v_cvt_pk_bf16_f32 v44, v36, v37
    ds_write_addtid_b32 v44 offset:18432
    v_pk_mul_f32 v[40:41], v[36:37], v[26:27] op_sel:[0,0] op_sel_hi:[1,0]
    v_pk_fma_f32 v[40:41], v[36:37], v[26:27], v[40:41] op_sel:[1,1,0] op_sel_hi:[0,1,1] neg_lo:[0,1,0]
    v_cvt_pk_bf16_f32 v45, v40, v41
    ds_write_addtid_b32 v45 offset:20512
    v_pk_mul_f32 v[42:43], v[40:41], v[26:27] op_sel:[0,0] op_sel_hi:[1,0]
    v_pk_fma_f32 v[42:43], v[40:41], v[26:27], v[42:43] op_sel:[1,1,0] op_sel_hi:[0,1,1] neg_lo:[0,1,0]
    v_cvt_pk_bf16_f32 v46, v42, v43
    ds_write_addtid_b32 v46 offset:22592
    v_pk_mul_f32 v[40:41], v[42:43], v[26:27] op_sel:[0,0] op_sel_hi:[1,0]
    v_pk_fma_f32 v[40:41], v[42:43], v[26:27], v[40:41] op_sel:[1,1,0] op_sel_hi:[0,1,1] neg_lo:[0,1,0]
    v_cvt_pk_bf16_f32 v47, v40, v41
    ds_write_addtid_b32 v47 offset:24672
    v_pk_mul_f32 v[38:39], v[36:37], v[24:25] op_sel:[0,0] op_sel_hi:[1,0]
    v_pk_fma_f32 v[38:39], v[36:37], v[24:25], v[38:39] op_sel:[1,1,0] op_sel_hi:[0,1,1] neg_lo:[0,1,0]
    v_cvt_pk_bf16_f32 v44, v38, v39
    ds_write_addtid_b32 v44 offset:26752
    v_pk_mul_f32 v[40:41], v[38:39], v[26:27] op_sel:[0,0] op_sel_hi:[1,0]
    v_pk_fma_f32 v[40:41], v[38:39], v[26:27], v[40:41] op_sel:[1,1,0] op_sel_hi:[0,1,1] neg_lo:[0,1,0]
    v_cvt_pk_bf16_f32 v45, v40, v41
    ds_write_addtid_b32 v45 offset:28832
    v_pk_mul_f32 v[42:43], v[40:41], v[26:27] op_sel:[0,0] op_sel_hi:[1,0]
    v_pk_fma_f32 v[42:43], v[40:41], v[26:27], v[42:43] op_sel:[1,1,0] op_sel_hi:[0,1,1] neg_lo:[0,1,0]
    v_cvt_pk_bf16_f32 v46, v42, v43
    ds_write_addtid_b32 v46 offset:30912
    v_pk_mul_f32 v[40:41], v[42:43], v[26:27] op_sel:[0,0] op_sel_hi:[1,0]
    v_pk_fma_f32 v[40:41], v[42:43], v[26:27], v[40:41] op_sel:[1,1,0] op_sel_hi:[0,1,1] neg_lo:[0,1,0]
    v_cvt_pk_bf16_f32 v47, v40, v41
    ds_write_addtid_b32 v47 offset:32992
    v_pk_mul_f32 v[36:37], v[38:39], v[24:25] op_sel:[0,0] op_sel_hi:[1,0]
    v_pk_fma_f32 v[36:37], v[38:39], v[24:25], v[36:37] op_sel:[1,1,0] op_sel_hi:[0,1,1] neg_lo:[0,1,0]
    v_cvt_pk_bf16_f32 v44, v36, v37
    ds_write_addtid_b32 v44 offset:35072
    v_pk_mul_f32 v[40:41], v[36:37], v[28:29] op_sel:[0,0] op_sel_hi:[1,0]
    v_pk_fma_f32 v[40:41], v[36:37], v[28:29], v[40:41] op_sel:[1,1,0] op_sel_hi:[0,1,1] neg_lo:[0,1,0]
    v_cvt_pk_bf16_f32 v45, v40, v41
    ds_write_addtid_b32 v45 offset:37152
    v_pk_mul_f32 v[38:39], v[36:37], v[24:25] op_sel:[0,0] op_sel_hi:[1,0]
    v_pk_fma_f32 v[38:39], v[36:37], v[24:25], v[38:39] op_sel:[1,1,0] op_sel_hi:[0,1,1] neg_lo:[0,1,0]
    v_cvt_pk_bf16_f32 v46, v38, v39
    ds_write_addtid_b32 v46 offset:39232
    v_pk_mul_f32 v[40:41], v[38:39], v[28:29] op_sel:[0,0] op_sel_hi:[1,0]
    v_pk_fma_f32 v[40:41], v[38:39], v[28:29], v[40:41] op_sel:[1,1,0] op_sel_hi:[0,1,1] neg_lo:[0,1,0]
    v_cvt_pk_bf16_f32 v47, v40, v41
    ds_write_addtid_b32 v47 offset:41312
    v_pk_mul_f32 v[36:37], v[38:39], v[24:25] op_sel:[0,0] op_sel_hi:[1,0]
    v_pk_fma_f32 v[36:37], v[38:39], v[24:25], v[36:37] op_sel:[1,1,0] op_sel_hi:[0,1,1] neg_lo:[0,1,0]
    v_cvt_pk_bf16_f32 v44, v36, v37
    ds_write_addtid_b32 v44 offset:43392
    v_pk_mul_f32 v[40:41], v[36:37], v[28:29] op_sel:[0,0] op_sel_hi:[1,0]
    v_pk_fma_f32 v[40:41], v[36:37], v[28:29], v[40:41] op_sel:[1,1,0] op_sel_hi:[0,1,1] neg_lo:[0,1,0]
    v_cvt_pk_bf16_f32 v45, v40, v41
    ds_write_addtid_b32 v45 offset:45472
    v_pk_mul_f32 v[38:39], v[36:37], v[24:25] op_sel:[0,0] op_sel_hi:[1,0]
    v_pk_fma_f32 v[38:39], v[36:37], v[24:25], v[38:39] op_sel:[1,1,0] op_sel_hi:[0,1,1] neg_lo:[0,1,0]
    v_cvt_pk_bf16_f32 v46, v38, v39
    ds_write_addtid_b32 v46 offset:47552
    v_pk_mul_f32 v[40:41], v[38:39], v[28:29] op_sel:[0,0] op_sel_hi:[1,0]
    v_pk_fma_f32 v[40:41], v[38:39], v[28:29], v[40:41] op_sel:[1,1,0] op_sel_hi:[0,1,1] neg_lo:[0,1,0]
    v_cvt_pk_bf16_f32 v47, v40, v41
    ds_write_addtid_b32 v47 offset:49632
    ds_read_b128 v[80:83], v2 offset:18432
    ds_read_b128 v[84:87], v2 offset:18496
    ds_read_b128 v[88:91], v2 offset:18560
    ds_read_b128 v[92:95], v2 offset:18624
    v_pk_mul_f32 v[36:37], v[38:39], v[24:25] op_sel:[0,0] op_sel_hi:[1,0]
    v_pk_fma_f32 v[36:37], v[38:39], v[24:25], v[36:37] op_sel:[1,1,0] op_sel_hi:[0,1,1] neg_lo:[0,1,0]
    v_cvt_pk_bf16_f32 v44, v36, v37
    ds_write_addtid_b32 v44 offset:18432
    v_pk_mul_f32 v[38:39], v[36:37], v[24:25] op_sel:[0,0] op_sel_hi:[1,0]
    v_pk_fma_f32 v[38:39], v[36:37], v[24:25], v[38:39] op_sel:[1,1,0] op_sel_hi:[0,1,1] neg_lo:[0,1,0]
    v_cvt_pk_bf16_f32 v45, v38, v39
    ds_write_addtid_b32 v45 offset:20512
    v_pk_mul_f32 v[36:37], v[38:39], v[24:25] op_sel:[0,0] op_sel_hi:[1,0]
    v_pk_fma_f32 v[36:37], v[38:39], v[24:25], v[36:37] op_sel:[1,1,0] op_sel_hi:[0,1,1] neg_lo:[0,1,0]
    v_cvt_pk_bf16_f32 v46, v36, v37
    ds_write_addtid_b32 v46 offset:22592
    v_pk_mul_f32 v[38:39], v[36:37], v[24:25] op_sel:[0,0] op_sel_hi:[1,0]
    v_pk_fma_f32 v[38:39], v[36:37], v[24:25], v[38:39] op_sel:[1,1,0] op_sel_hi:[0,1,1] neg_lo:[0,1,0]
    v_cvt_pk_bf16_f32 v47, v38, v39
    ds_write_addtid_b32 v47 offset:24672
    v_pk_mul_f32 v[36:37], v[38:39], v[24:25] op_sel:[0,0] op_sel_hi:[1,0]
    v_pk_fma_f32 v[36:37], v[38:39], v[24:25], v[36:37] op_sel:[1,1,0] op_sel_hi:[0,1,1] neg_lo:[0,1,0]
    v_cvt_pk_bf16_f32 v44, v36, v37
    ds_write_addtid_b32 v44 offset:26752
    v_pk_mul_f32 v[38:39], v[36:37], v[24:25] op_sel:[0,0] op_sel_hi:[1,0]
    v_pk_fma_f32 v[38:39], v[36:37], v[24:25], v[38:39] op_sel:[1,1,0] op_sel_hi:[0,1,1] neg_lo:[0,1,0]
    v_cvt_pk_bf16_f32 v45, v38, v39
    ds_write_addtid_b32 v45 offset:28832
    v_pk_mul_f32 v[36:37], v[38:39], v[24:25] op_sel:[0,0] op_sel_hi:[1,0]
    v_pk_fma_f32 v[36:37], v[38:39], v[24:25], v[36:37] op_sel:[1,1,0] op_sel_hi:[0,1,1] neg_lo:[0,1,0]
    v_cvt_pk_bf16_f32 v46, v36, v37
    ds_write_addtid_b32 v46 offset:30912
    s_cbranch_scc0 L_sk
    s_nop 0
    global_load_dwordx4 v[176:179], v238, s[40:41] offset:-4096 sc1
    global_load_dwordx4 v[180:183], v238, s[40:41] offset:0 sc1
L_sk:
    v_pk_mul_f32 v[38:39], v[36:37], v[24:25] op_sel:[0,0] op_sel_hi:[1,0]
    v_pk_fma_f32 v[38:39], v[36:37], v[24:25], v[38:39] op_sel:[1,1,0] op_sel_hi:[0,1,1] neg_lo:[0,1,0]
    v_cvt_pk_bf16_f32 v47, v38, v39
    ds_write_addtid_b32 v47 offset:32992
    v_pk_mul_f32 v[36:37], v[38:39], v[24:25] op_sel:[0,0] op_sel_hi:[1,0]
    v_pk_fma_f32 v[36:37], v[38:39], v[24:25], v[36:37] op_sel:[1,1,0] op_sel_hi:[0,1,1] neg_lo:[0,1,0]
    v_cvt_pk_bf16_f32 v44, v36, v37
    ds_write_addtid_b32 v44 offset:35072
    ds_read_b128 v[112:115], v2 offset:18432
    ds_read_b128 v[116:119], v2 offset:18496
    ds_read_b128 v[120:123], v2 offset:18560
    ds_read_b128 v[124:127], v2 offset:18624
    s_waitcnt lgkmcnt(4)
    v_mfma_f32_16x16x32_bf16 v[96:99], v[64:67], v[48:51], 0
    v_mfma_f32_16x16x32_bf16 v[96:99], v[68:71], v[52:55], v[96:99]
    v_mfma_f32_16x16x32_bf16 v[96:99], v[72:75], v[56:59], v[96:99]
    v_mfma_f32_16x16x32_bf16 v[96:99], v[76:79], v[60:63], v[96:99]
    v_mfma_f32_16x16x32_bf16 v[100:103], v[80:83], v[48:51], 0
    v_mfma_f32_16x16x32_bf16 v[100:103], v[84:87], v[52:55], v[100:103]
    v_mfma_f32_16x16x32_bf16 v[100:103], v[88:91], v[56:59], v[100:103]
    v_mfma_f32_16x16x32_bf16 v[100:103], v[92:95], v[60:63], v[100:103]
    s_waitcnt lgkmcnt(0)
    v_mfma_f32_16x16x32_bf16 v[104:107], v[112:115], v[48:51], 0
    v_mfma_f32_16x16x32_bf16 v[104:107], v[116:119], v[52:55], v[104:107]
    v_mfma_f32_16x16x32_bf16 v[104:107], v[120:123], v[56:59], v[104:107]
    v_mfma_f32_16x16x32_bf16 v[104:107], v[124:127], v[60:63], v[104:107]
    s_cbranch_scc1 L_row
    v_fmac_f32 v96, s60, v207
    v_and_b32 v2, 15, v1
    v_and_b32 v7, 48, v1
    s_mul_i32 s7, s43, 4608
    v_lshl_add_u32 v4, v2, 5, v7
    v_add_u32 v4, s7, v4
    s_lshl_b32 s7, s43, 13
    s_add_u32 s7, s7, 106240
    v_lshlrev_b32 v5, 3, v2
    v_and_b32 v5, 48, v5
    v_xor_b32_e64 v5, v5, v7
    v_lshl_add_u32 v5, v2, 6, v5
    v_add_u32 v5, s7, v5
    v_mov_b32 v7, v197
    v_lshlrev_b32_e64 v6, 4, v1
    v_add_u32 v6, 112384, v6
    s_waitcnt vmcnt(2)
    ds_write_b128 v252, v[244:247] offset:51712
    s_waitcnt lgkmcnt(0)
    s_barrier
    ds_read_b128 v[136:139], v3 offset:0
    ds_read_b128 v[140:143], v3 offset:1024
    ds_read_b128 v[144:147], v3 offset:2048
    s_waitcnt lgkmcnt(2)
    v_pk_add_f32 v[136:137], v[136:137], v[96:97]
    v_pk_add_f32 v[138:139], v[138:139], v[98:99]
    v_cvt_pk_bf16_f32 v228, v136, v137
    v_cvt_pk_bf16_f32 v229, v138, v139
    v_cvt_pk_bf16_f32 v154, v137, v138
    ds_write_b64 v198, v[228:229]
    ds_write_b32 v198, v228 offset:2692
    ds_write_b32 v198, v229 offset:2696
    ds_write_b16 v198, v228 offset:1346
    ds_write_b32 v198, v154 offset:1348
    ds_write_b16_d16_hi v198, v229 offset:1352
    ds_write_b16 v198, v228 offset:4038
    ds_write_b32 v198, v154 offset:4040
    ds_write_b16_d16_hi v198, v229 offset:4044
    s_waitcnt lgkmcnt(10)
    v_pk_add_f32 v[140:141], v[140:141], v[100:101]
    v_pk_add_f32 v[142:143], v[142:143], v[102:103]
    s_waitcnt lgkmcnt(9)
    v_pk_add_f32 v[144:145], v[144:145], v[104:105]
    v_pk_add_f32 v[146:147], v[146:147], v[106:107]
    ds_read_b64_tr_b16 v[64:65], v196 offset:16
    ds_read_b64_tr_b16 v[66:67], v196 offset:8
    ds_read_b64_tr_b16 v[68:69], v196 offset:80
    ds_read_b64_tr_b16 v[70:71], v196 offset:72
    ds_read_b64_tr_b16 v[72:73], v196 offset:144
    ds_read_b64_tr_b16 v[74:75], v196 offset:136
    ds_read_b64_tr_b16 v[76:77], v196 offset:208
    ds_read_b64_tr_b16 v[78:79], v196 offset:200
    ds_read_b64_tr_b16 v[80:81], v196 offset:272
    ds_read_b64_tr_b16 v[82:83], v196 offset:264
    ds_read_b64_tr_b16 v[84:85], v196 offset:336
    ds_read_b64_tr_b16 v[86:87], v196 offset:328
    ds_read_b64_tr_b16 v[88:89], v196 offset:400
    ds_read_b64_tr_b16 v[90:91], v196 offset:392
    ds_read_b64_tr_b16 v[92:93], v196 offset:464
    ds_read_b64_tr_b16 v[94:95], v196 offset:456
    v_cvt_pk_bf16_f32 v152, v140, v140
    v_cvt_pk_bf16_f32 v149, v140, v141
    v_cvt_pk_bf16_f32 v150, v142, v142
    v_cvt_pk_bf16_f32 v151, v142, v143
    v_cvt_pk_bf16_f32 v153, v141, v142
    v_readlane_b32 s7, v229, 63
    v_readlane_b32 s73, v152, 0
    v_mov_b32 v148, v152
    v_mov_b32 v230, v149
    v_mov_b32 v231, v151
    s_pack_hh_b32_b16 s7, s7, s73
    v_cvt_pk_bf16_f32 v232, v144, v145
    v_cvt_pk_bf16_f32 v233, v146, v147
    v_writelane_b32 v148, s7, 0
    s_mov_b32 exec_lo, 0
    s_mov_b32 exec_hi, 1
    v_mov_b32_e64 v149, v152
    v_and_b32 v153, 0xffff, v152
    v_mov_b32 v150, 0
    v_mov_b32 v151, 0
    s_mov_b64 exec, -1
    s_mov_b32 exec_hi, 1
    ds_write_b128 v199, v[148:151] offset:1360
    ds_write2_b32 v200, v148, v149 offset0:5 offset1:6
    ds_write2_b32 v200, v150, v151 offset0:7 offset1:8
    ds_write_b16 v199, v148 offset:14
    ds_write2_b32 v199, v152, v153 offset0:4 offset1:5
    ds_write_b32 v199, v150 offset:24
    ds_write_b16_d16_hi v199, v151 offset:28
    ds_write_b16 v201, v148 offset:18
    ds_write2_b32 v201, v152, v153 offset0:5 offset1:6
    ds_write_b32 v201, v150 offset:28
    ds_write_b16_d16_hi v201, v151 offset:32
    s_mov_b64 exec, -1
    v_mov_b32 v3, v252
    v_mov_b32 v2, v254
    s_barrier
    ds_read_b128 v[8:11], v4 offset:480
    ds_read_b128 v[12:15], v4 offset:416
    ds_read_b128 v[16:19], v4 offset:352
    ds_read_b64_tr_b16 v[96:97], v196 offset:528
    ds_read_b64_tr_b16 v[98:99], v196 offset:520
    s_waitcnt lgkmcnt(4)
    v_mfma_f32_16x16x32_bf16 v[48:51], v[64:67], v[8:11], 0
    ds_read_b128 v[20:23], v4 offset:288
    ds_read_b64_tr_b16 v[100:101], v196 offset:592
    ds_read_b64_tr_b16 v[102:103], v196 offset:584
    s_waitcnt lgkmcnt(6)
    v_mfma_f32_16x16x32_bf16 v[48:51], v[68:71], v[12:15], v[48:51]
    ds_read_b128 v[24:27], v4 offset:224
    ds_read_b64_tr_b16 v[104:105], v196 offset:656
    ds_read_b64_tr_b16 v[106:107], v196 offset:648
    s_waitcnt lgkmcnt(8)
    v_mfma_f32_16x16x32_bf16 v[48:51], v[72:75], v[16:19], v[48:51]
    ds_read_b128 v[28:31], v4 offset:160
    ds_read_b64_tr_b16 v[108:109], v196 offset:720
    ds_read_b64_tr_b16 v[110:111], v196 offset:712
    s_waitcnt lgkmcnt(8)
    v_mfma_f32_16x16x32_bf16 v[48:51], v[76:79], v[20:23], v[48:51]
    ds_read_b128 v[32:35], v4 offset:96
    ds_read_b64_tr_b16 v[112:113], v196 offset:784
    ds_read_b64_tr_b16 v[114:115], v196 offset:776
    s_waitcnt lgkmcnt(8)
    v_mfma_f32_16x16x32_bf16 v[48:51], v[80:83], v[24:27], v[48:51]
    ds_read_b128 v[36:39], v4 offset:32
    ds_read_b64_tr_b16 v[116:117], v196 offset:848
    ds_read_b64_tr_b16 v[118:119], v196 offset:840
    s_waitcnt lgkmcnt(8)
    v_mfma_f32_16x16x32_bf16 v[48:51], v[84:87], v[28:31], v[48:51]
    ds_read_b128 v[40:43], v4 offset:992
    ds_read_b64_tr_b16 v[120:121], v196 offset:912
    ds_read_b64_tr_b16 v[122:123], v196 offset:904
    s_waitcnt lgkmcnt(8)
    v_mfma_f32_16x16x32_bf16 v[48:51], v[88:91], v[32:35], v[48:51]
    ds_read_b128 v[44:47], v4 offset:928
    ds_read_b64_tr_b16 v[124:125], v196 offset:976
    ds_read_b64_tr_b16 v[126:127], v196 offset:968
    s_waitcnt lgkmcnt(8)
    v_mfma_f32_16x16x32_bf16 v[48:51], v[92:95], v[36:39], v[48:51]
    ds_read_b64_tr_b16 v[128:129], v196 offset:1040
    ds_read_b64_tr_b16 v[130:131], v196 offset:1032
    s_waitcnt lgkmcnt(7)
    v_mfma_f32_16x16x32_bf16 v[52:55], v[64:67], v[40:43], 0
    v_mfma_f32_16x16x32_bf16 v[56:59], v[96:99], v[40:43], 0
    s_nop 2
    ds_write_b128 v5, v[48:51] offset:0
    v_mfma_f32_16x16x32_bf16 v[52:55], v[96:99], v[8:11], v[52:55]
    ds_read_b128 v[40:43], v4 offset:864
    s_waitcnt lgkmcnt(6)
    v_mfma_f32_16x16x32_bf16 v[52:55], v[68:71], v[44:47], v[52:55]
    ds_read_b128 v[8:11], v4 offset:800
    v_mfma_f32_16x16x32_bf16 v[56:59], v[100:103], v[44:47], v[56:59]
    v_mfma_f32_16x16x32_bf16 v[52:55], v[100:103], v[12:15], v[52:55]
    ds_read_b128 v[44:47], v4 offset:736
    s_waitcnt lgkmcnt(3)
    s_barrier
    s_waitcnt lgkmcnt(2)
    v_mfma_f32_16x16x32_bf16 v[52:55], v[72:75], v[40:43], v[52:55]
    ds_read_b128 v[12:15], v4 offset:672
    v_mfma_f32_16x16x32_bf16 v[56:59], v[104:107], v[40:43], v[56:59]
    ds_read_b128 v[208:211], v6 offset:17408
    v_mfma_f32_16x16x32_bf16 v[52:55], v[104:107], v[16:19], v[52:55]
    ds_read_b128 v[40:43], v4 offset:608
    s_waitcnt lgkmcnt(4)
    v_mfma_f32_16x16x32_bf16 v[52:55], v[76:79], v[8:11], v[52:55]
    ds_read_b128 v[16:19], v4 offset:544
    v_mfma_f32_16x16x32_bf16 v[56:59], v[108:111], v[8:11], v[56:59]
    ds_read_b128 v[176:179], v6 offset:0
    v_mfma_f32_16x16x32_bf16 v[52:55], v[108:111], v[20:23], v[52:55]
    ds_read_b128 v[8:11], v4 offset:480
    s_waitcnt lgkmcnt(6)
    v_mfma_f32_16x16x32_bf16 v[52:55], v[80:83], v[44:47], v[52:55]
    ds_read_b128 v[20:23], v4 offset:464
    v_mfma_f32_16x16x32_bf16 v[56:59], v[112:115], v[44:47], v[56:59]
    ds_read_b128 v[180:183], v6 offset:1024
    v_mfma_f32_16x16x32_bf16 v[52:55], v[112:115], v[24:27], v[52:55]
    ds_read_b128 v[44:47], v4 offset:1504
    s_waitcnt lgkmcnt(8)
    v_mfma_f32_16x16x32_bf16 v[52:55], v[84:87], v[12:15], v[52:55]
    ds_read_b128 v[24:27], v4 offset:1440
    v_mfma_f32_16x16x32_bf16 v[56:59], v[116:119], v[12:15], v[56:59]
    ds_read_b128 v[184:187], v6 offset:8192
    v_mfma_f32_16x16x32_bf16 v[52:55], v[116:119], v[28:31], v[52:55]
    ds_read_b128 v[12:15], v4 offset:1376
    s_waitcnt lgkmcnt(10)
    s_mov_b32 exec_lo, 0
    ds_write_b16 v204, v230
    ds_write_b16_d16_hi v202, v230 offset:32
    ds_write_b16 v203, v231
    ds_write_b16_d16_hi v202, v231
    s_mov_b32 exec_lo, -1
    s_mov_b32 exec_hi, 1
    ds_write_b16 v206, v232
    s_mov_b32 exec_hi, 0
    ds_write_b16_d16_hi v205, v232 offset:64
    ds_write_b16 v205, v233 offset:32
    ds_write_b16_d16_hi v205, v233
    s_mov_b64 exec, -1
    v_readlane_b32 s7, v232, 0
    s_nop 0
    s_pack_ll_b32_b16 s7, s7, s7
    v_and_b32 v132, s7, v208
    v_and_b32 v133, s7, v209
    v_and_b32 v134, s7, v210
    v_and_b32 v135, s7, v211
    s_waitcnt lgkmcnt(15)
    v_mfma_f32_16x16x32_bf16 v[52:55], v[88:91], v[40:43], v[52:55]
    ds_read_b128 v[28:31], v4 offset:1312
    v_mfma_f32_16x16x32_bf16 v[56:59], v[120:123], v[40:43], v[56:59]
    ds_read_b128 v[188:191], v6 offset:9216
    v_mfma_f32_16x16x32_bf16 v[52:55], v[120:123], v[32:35], v[52:55]
    ds_read_b128 v[40:43], v4 offset:1248
    v_mfma_f32_16x16x32_bf16 v[52:55], v[92:95], v[16:19], v[52:55]
    ds_read_b128 v[32:35], v4 offset:1184
    v_mfma_f32_16x16x32_bf16 v[56:59], v[124:127], v[16:19], v[56:59]
    ds_read_b128 v[192:195], v6 offset:16384
    v_mfma_f32_16x16x32_bf16 v[52:55], v[124:127], v[36:39], v[52:55]
    ds_read_b128 v[16:19], v4 offset:1120
    s_waitcnt vmcnt(0)
    ds_write_b128 v252, v[248:251] offset:59904
    s_waitcnt lgkmcnt(2)
    v_mfma_f32_16x16x32_bf16 v[196:199], v[8:11], v[176:179], 0
    ds_read_b128 v[36:39], v4 offset:1056
    v_mfma_f32_16x16x32_bf16 v[244:247], v[8:11], v[180:183], 0
    ds_read2_b32 v[136:137], v7 offset0:32 offset1:33
    v_mfma_f32_16x16x32_bf16 v[200:203], v[8:11], v[184:187], 0
    ds_read2_b32 v[138:139], v7 offset0:34 offset1:35
    ds_write_b128 v5, v[52:55] offset:1024
    v_mfma_f32_16x16x32_bf16 v[56:59], v[128:131], v[8:11], v[56:59]
    ds_read2_b32 v[140:141], v7 offset0:96 offset1:97
    v_mfma_f32_16x16x32_bf16 v[228:231], v[8:11], v[188:191], 0
    ds_read2_b32 v[142:143], v7 offset0:98 offset1:99
    v_mfma_f32_16x16x32_bf16 v[248:251], v[20:23], v[180:183], 0
    ds_read_b128 v[8:11], v4 offset:992
    v_cvt_pk_bf16_f32 v196, v196, v244
    v_cvt_pk_bf16_f32 v197, v197, v245
    v_mfma_f32_16x16x32_bf16 v[252:255], v[20:23], v[192:195], 0
    ds_read2_b32 v[144:145], v7 offset0:16 offset1:17
    v_cvt_pk_bf16_f32 v198, v198, v246
    v_cvt_pk_bf16_f32 v199, v199, v247
    v_mfma_f32_16x16x32_bf16 v[56:59], v[64:67], v[44:47], v[56:59]
    ds_read_b128 v[20:23], v4 offset:976
    v_mfma_f32_16x16x32_bf16 v[60:63], v[96:99], v[44:47], 0
    ds_read2_b32 v[146:147], v7 offset0:18 offset1:19
    s_waitcnt lgkmcnt(6)
    s_barrier
    v_mfma_f32_16x16x32_bf16 v[56:59], v[68:71], v[24:27], v[56:59]
    ds_read_b128 v[44:47], v4 offset:2016
    v_cvt_pk_bf16_f32 v200, v200, v248
    v_cvt_pk_bf16_f32 v201, v201, v249
    v_mfma_f32_16x16x32_bf16 v[60:63], v[100:103], v[24:27], v[60:63]
    ds_read2_b32 v[148:149], v7 offset0:80 offset1:81
    v_cvt_pk_bf16_f32 v202, v202, v250
    v_cvt_pk_bf16_f32 v203, v203, v251
    v_mfma_f32_16x16x32_bf16 v[56:59], v[72:75], v[12:15], v[56:59]
    ds_read_b128 v[24:27], v4 offset:1952
    v_cvt_pk_bf16_f32 v228, v228, v252
    v_cvt_pk_bf16_f32 v229, v229, v253
    v_mfma_f32_16x16x32_bf16 v[60:63], v[104:107], v[12:15], v[60:63]
    ds_read2_b32 v[150:151], v7 offset0:82 offset1:83
    v_cvt_pk_bf16_f32 v230, v230, v254
    v_cvt_pk_bf16_f32 v231, v231, v255
    v_mfma_f32_16x16x32_bf16 v[56:59], v[76:79], v[28:31], v[56:59]
    ds_read_b128 v[12:15], v4 offset:1888
    v_mfma_f32_16x16x32_bf16 v[60:63], v[108:111], v[28:31], v[60:63]
    ds_read2_b32 v[152:153], v7 offset0:0 offset1:1
    v_mfma_f32_16x16x32_bf16 v[56:59], v[80:83], v[40:43], v[56:59]
    ds_read_b128 v[28:31], v4 offset:1824
    v_mfma_f32_16x16x32_bf16 v[60:63], v[112:115], v[40:43], v[60:63]
    ds_read2_b32 v[154:155], v7 offset0:2 offset1:3
    v_mfma_f32_16x16x32_bf16 v[56:59], v[84:87], v[32:35], v[56:59]
    ds_read_b128 v[40:43], v4 offset:1760
    v_mfma_f32_16x16x32_bf16 v[60:63], v[116:119], v[32:35], v[60:63]
    ds_read2_b32 v[156:157], v7 offset0:64 offset1:65
    v_mfma_f32_16x16x32_bf16 v[56:59], v[88:91], v[16:19], v[56:59]
    ds_read_b128 v[32:35], v4 offset:1696
    v_mfma_f32_16x16x32_bf16 v[60:63], v[120:123], v[16:19], v[60:63]
    ds_read2_b32 v[158:159], v7 offset0:66 offset1:67
    v_mfma_f32_16x16x32_bf16 v[56:59], v[196:199], v[136:139], v[56:59]
    ds_read_b128 v[16:19], v4 offset:1632
    s_waitcnt lgkmcnt(15)
    v_mfma_f32_16x16x32_bf16 v[56:59], v[200:203], v[140:143], v[56:59]
    ds_read2_b32 v[160:161], v7 offset0:176 offset1:177
    v_mfma_f32_16x16x32_bf16 v[56:59], v[92:95], v[36:39], v[56:59]
    ds_read2_b32 v[162:163], v7 offset0:178 offset1:179
    v_mfma_f32_16x16x32_bf16 v[60:63], v[124:127], v[36:39], v[60:63]
    ds_read2_b32 v[164:165], v7 offset0:160 offset1:161
    v_mfma_f32_16x16x32_bf16 v[204:207], v[8:11], v[176:179], 0
    ds_read_b128 v[36:39], v4 offset:1568
    v_mfma_f32_16x16x32_bf16 v[244:247], v[8:11], v[180:183], 0
    ds_read2_b32 v[166:167], v7 offset0:162 offset1:163
    v_mfma_f32_16x16x32_bf16 v[208:211], v[8:11], v[184:187], 0
    ds_read2_b32 v[168:169], v7 offset0:144 offset1:145
    ds_write_b128 v5, v[56:59] offset:2048
    v_mfma_f32_16x16x32_bf16 v[60:63], v[128:131], v[8:11], v[60:63]
    ds_read2_b32 v[170:171], v7 offset0:146 offset1:147
    v_mfma_f32_16x16x32_bf16 v[232:235], v[8:11], v[188:191], 0
    ds_read2_b32 v[172:173], v7 offset0:128 offset1:129
    s_waitcnt lgkmcnt(15)
    v_mfma_f32_16x16x32_bf16 v[248:251], v[20:23], v[180:183], 0
    ds_read_b128 v[8:11], v4 offset:1504
    v_cvt_pk_bf16_f32 v204, v204, v244
    v_cvt_pk_bf16_f32 v205, v205, v245
    v_mfma_f32_16x16x32_bf16 v[252:255], v[20:23], v[192:195], 0
    ds_read2_b32 v[174:175], v7 offset0:130 offset1:131
    v_cvt_pk_bf16_f32 v206, v206, v246
    v_cvt_pk_bf16_f32 v207, v207, v247
    v_mfma_f32_16x16x32_bf16 v[60:63], v[64:67], v[44:47], v[60:63]
    ds_read_b128 v[20:23], v4 offset:1488
    v_mfma_f32_16x16x32_bf16 v[48:51], v[96:99], v[44:47], 0
    s_waitcnt lgkmcnt(5)
    s_barrier
    v_mfma_f32_16x16x32_bf16 v[60:63], v[68:71], v[24:27], v[60:63]
    ds_read_b128 v[44:47], v4 offset:480
    v_cvt_pk_bf16_f32 v208, v208, v248
    v_cvt_pk_bf16_f32 v209, v209, v249
    v_mfma_f32_16x16x32_bf16 v[48:51], v[100:103], v[24:27], v[48:51]
    v_cvt_pk_bf16_f32 v210, v210, v250
    v_cvt_pk_bf16_f32 v211, v211, v251
    v_mfma_f32_16x16x32_bf16 v[60:63], v[72:75], v[12:15], v[60:63]
    ds_read_b128 v[24:27], v4 offset:2528
    v_cvt_pk_bf16_f32 v232, v232, v252
    v_cvt_pk_bf16_f32 v233, v233, v253
    v_mfma_f32_16x16x32_bf16 v[48:51], v[104:107], v[12:15], v[48:51]
    v_cvt_pk_bf16_f32 v234, v234, v254
    v_cvt_pk_bf16_f32 v235, v235, v255
    v_mfma_f32_16x16x32_bf16 v[60:63], v[76:79], v[28:31], v[60:63]
    ds_read_b128 v[12:15], v4 offset:2464
    v_mfma_f32_16x16x32_bf16 v[48:51], v[108:111], v[28:31], v[48:51]
    v_mfma_f32_16x16x32_bf16 v[60:63], v[196:199], v[144:147], v[60:63]
    ds_read_b128 v[28:31], v4 offset:2400
    v_mfma_f32_16x16x32_bf16 v[60:63], v[200:203], v[148:151], v[60:63]
    v_mfma_f32_16x16x32_bf16 v[60:63], v[80:83], v[40:43], v[60:63]
    v_mfma_f32_16x16x32_bf16 v[48:51], v[112:115], v[40:43], v[48:51]
    v_mfma_f32_16x16x32_bf16 v[60:63], v[84:87], v[32:35], v[60:63]
    ds_read_b128 v[40:43], v4 offset:2336
    v_mfma_f32_16x16x32_bf16 v[48:51], v[116:119], v[32:35], v[48:51]
    v_mfma_f32_16x16x32_bf16 v[60:63], v[88:91], v[16:19], v[60:63]
    ds_read_b128 v[32:35], v4 offset:2272
    v_mfma_f32_16x16x32_bf16 v[48:51], v[120:123], v[16:19], v[48:51]
    v_mfma_f32_16x16x32_bf16 v[60:63], v[204:207], v[136:139], v[60:63]
    ds_read_b128 v[16:19], v4 offset:2208
    v_mfma_f32_16x16x32_bf16 v[60:63], v[208:211], v[140:143], v[60:63]
    v_mfma_f32_16x16x32_bf16 v[60:63], v[92:95], v[36:39], v[60:63]
    v_mfma_f32_16x16x32_bf16 v[48:51], v[124:127], v[36:39], v[48:51]
    s_waitcnt lgkmcnt(9)
    v_mfma_f32_16x16x32_bf16 v[212:215], v[8:11], v[176:179], 0
    ds_read_b128 v[36:39], v4 offset:2144
    v_mfma_f32_16x16x32_bf16 v[244:247], v[8:11], v[180:183], 0
    v_mfma_f32_16x16x32_bf16 v[216:219], v[8:11], v[184:187], 0
    s_nop 1
    ds_write_b128 v5, v[60:63] offset:3072
    v_mfma_f32_16x16x32_bf16 v[48:51], v[128:131], v[8:11], v[48:51]
    v_mfma_f32_16x16x32_bf16 v[236:239], v[8:11], v[188:191], 0
    s_waitcnt lgkmcnt(9)
    v_mfma_f32_16x16x32_bf16 v[248:251], v[20:23], v[180:183], 0
    ds_read_b128 v[8:11], v4 offset:2080
    v_cvt_pk_bf16_f32 v212, v212, v244
    v_cvt_pk_bf16_f32 v213, v213, v245
    v_mfma_f32_16x16x32_bf16 v[252:255], v[20:23], v[192:195], 0
    v_cvt_pk_bf16_f32 v214, v214, v246
    v_cvt_pk_bf16_f32 v215, v215, v247
    s_waitcnt lgkmcnt(9)
    v_mfma_f32_16x16x32_bf16 v[48:51], v[132:135], v[44:47], v[48:51]
    ds_read_b128 v[20:23], v4 offset:2016
    v_mfma_f32_16x16x32_bf16 v[48:51], v[204:207], v[144:147], v[48:51]
    ds_read_b128 v[44:47], v4 offset:2000
    s_waitcnt lgkmcnt(3)
    s_barrier
    v_mfma_f32_16x16x32_bf16 v[48:51], v[208:211], v[148:151], v[48:51]
    v_cvt_pk_bf16_f32 v216, v216, v248
    v_cvt_pk_bf16_f32 v217, v217, v249
    v_mfma_f32_16x16x32_bf16 v[48:51], v[196:199], v[152:155], v[48:51]
    v_cvt_pk_bf16_f32 v218, v218, v250
    v_cvt_pk_bf16_f32 v219, v219, v251
    v_mfma_f32_16x16x32_bf16 v[48:51], v[200:203], v[156:159], v[48:51]
    v_cvt_pk_bf16_f32 v236, v236, v252
    v_cvt_pk_bf16_f32 v237, v237, v253
    v_mfma_f32_16x16x32_bf16 v[48:51], v[228:231], v[160:163], v[48:51]
    v_cvt_pk_bf16_f32 v238, v238, v254
    v_cvt_pk_bf16_f32 v239, v239, v255
    v_mfma_f32_16x16x32_bf16 v[48:51], v[64:67], v[24:27], v[48:51]
    v_mfma_f32_16x16x32_bf16 v[52:55], v[96:99], v[24:27], 0
    v_mfma_f32_16x16x32_bf16 v[48:51], v[68:71], v[12:15], v[48:51]
    ds_read_b128 v[24:27], v4 offset:992
    v_mfma_f32_16x16x32_bf16 v[52:55], v[100:103], v[12:15], v[52:55]
    v_mfma_f32_16x16x32_bf16 v[48:51], v[72:75], v[28:31], v[48:51]
    ds_read_b128 v[12:15], v4 offset:3040
    v_mfma_f32_16x16x32_bf16 v[52:55], v[104:107], v[28:31], v[52:55]
    v_mfma_f32_16x16x32_bf16 v[48:51], v[76:79], v[40:43], v[48:51]
    ds_read_b128 v[28:31], v4 offset:2976
    v_mfma_f32_16x16x32_bf16 v[52:55], v[108:111], v[40:43], v[52:55]
    v_mfma_f32_16x16x32_bf16 v[48:51], v[80:83], v[32:35], v[48:51]
    ds_read_b128 v[40:43], v4 offset:2912
    v_mfma_f32_16x16x32_bf16 v[52:55], v[112:115], v[32:35], v[52:55]
    v_mfma_f32_16x16x32_bf16 v[48:51], v[84:87], v[16:19], v[48:51]
    ds_read_b128 v[32:35], v4 offset:2848
    v_mfma_f32_16x16x32_bf16 v[52:55], v[116:119], v[16:19], v[52:55]
    v_mfma_f32_16x16x32_bf16 v[48:51], v[88:91], v[36:39], v[48:51]
    ds_read_b128 v[16:19], v4 offset:2784
    v_mfma_f32_16x16x32_bf16 v[52:55], v[120:123], v[36:39], v[52:55]
    v_mfma_f32_16x16x32_bf16 v[48:51], v[212:215], v[136:139], v[48:51]
    ds_read_b128 v[36:39], v4 offset:2720
    v_mfma_f32_16x16x32_bf16 v[48:51], v[216:219], v[140:143], v[48:51]
    s_waitcnt lgkmcnt(9)
    v_mfma_f32_16x16x32_bf16 v[48:51], v[92:95], v[8:11], v[48:51]
    v_mfma_f32_16x16x32_bf16 v[52:55], v[124:127], v[8:11], v[52:55]
    s_waitcnt lgkmcnt(8)
    v_mfma_f32_16x16x32_bf16 v[220:223], v[20:23], v[176:179], 0
    ds_read_b128 v[8:11], v4 offset:2656
    v_mfma_f32_16x16x32_bf16 v[244:247], v[20:23], v[180:183], 0
    v_mfma_f32_16x16x32_bf16 v[224:227], v[20:23], v[184:187], 0
    s_nop 1
    ds_write_b128 v5, v[48:51] offset:4096
    v_mfma_f32_16x16x32_bf16 v[52:55], v[128:131], v[20:23], v[52:55]
    v_mfma_f32_16x16x32_bf16 v[240:243], v[20:23], v[188:191], 0
    s_waitcnt lgkmcnt(9)
    v_mfma_f32_16x16x32_bf16 v[248:251], v[44:47], v[180:183], 0
    ds_read_b128 v[20:23], v4 offset:2592
    v_cvt_pk_bf16_f32 v220, v220, v244
    v_cvt_pk_bf16_f32 v221, v221, v245
    v_mfma_f32_16x16x32_bf16 v[252:255], v[44:47], v[192:195], 0
    v_cvt_pk_bf16_f32 v222, v222, v246
    v_cvt_pk_bf16_f32 v223, v223, v247
    s_waitcnt lgkmcnt(9)
    v_mfma_f32_16x16x32_bf16 v[52:55], v[132:135], v[24:27], v[52:55]
    ds_read_b128 v[44:47], v4 offset:2528
    v_mfma_f32_16x16x32_bf16 v[52:55], v[212:215], v[144:147], v[52:55]
    ds_read_b128 v[24:27], v4 offset:2512
    s_waitcnt lgkmcnt(3)
    s_barrier
    v_mfma_f32_16x16x32_bf16 v[52:55], v[216:219], v[148:151], v[52:55]
    v_cvt_pk_bf16_f32 v224, v224, v248
    v_cvt_pk_bf16_f32 v225, v225, v249
    v_mfma_f32_16x16x32_bf16 v[52:55], v[204:207], v[152:155], v[52:55]
    v_cvt_pk_bf16_f32 v226, v226, v250
    v_cvt_pk_bf16_f32 v227, v227, v251
    v_mfma_f32_16x16x32_bf16 v[52:55], v[208:211], v[156:159], v[52:55]
    v_cvt_pk_bf16_f32 v240, v240, v252
    v_cvt_pk_bf16_f32 v241, v241, v253
    v_mfma_f32_16x16x32_bf16 v[52:55], v[232:235], v[160:163], v[52:55]
    v_cvt_pk_bf16_f32 v242, v242, v254
    v_cvt_pk_bf16_f32 v243, v243, v255
    v_mfma_f32_16x16x32_bf16 v[52:55], v[228:231], v[164:167], v[52:55]
    v_mfma_f32_16x16x32_bf16 v[52:55], v[64:67], v[12:15], v[52:55]
    v_mfma_f32_16x16x32_bf16 v[56:59], v[96:99], v[12:15], 0
    v_mfma_f32_16x16x32_bf16 v[52:55], v[68:71], v[28:31], v[52:55]
    ds_read_b128 v[12:15], v4 offset:1504
    v_mfma_f32_16x16x32_bf16 v[56:59], v[100:103], v[28:31], v[56:59]
    v_mfma_f32_16x16x32_bf16 v[52:55], v[72:75], v[40:43], v[52:55]
    ds_read_b128 v[28:31], v4 offset:3552
    v_mfma_f32_16x16x32_bf16 v[56:59], v[104:107], v[40:43], v[56:59]
    v_mfma_f32_16x16x32_bf16 v[52:55], v[76:79], v[32:35], v[52:55]
    ds_read_b128 v[40:43], v4 offset:3488
    v_mfma_f32_16x16x32_bf16 v[56:59], v[108:111], v[32:35], v[56:59]
    v_mfma_f32_16x16x32_bf16 v[52:55], v[80:83], v[16:19], v[52:55]
    ds_read_b128 v[32:35], v4 offset:3424
    v_mfma_f32_16x16x32_bf16 v[56:59], v[112:115], v[16:19], v[56:59]
    v_mfma_f32_16x16x32_bf16 v[52:55], v[84:87], v[36:39], v[52:55]
    ds_read_b128 v[16:19], v4 offset:3360
    v_mfma_f32_16x16x32_bf16 v[56:59], v[116:119], v[36:39], v[56:59]
    v_mfma_f32_16x16x32_bf16 v[52:55], v[88:91], v[8:11], v[52:55]
    ds_read_b128 v[36:39], v4 offset:3296
    v_mfma_f32_16x16x32_bf16 v[56:59], v[120:123], v[8:11], v[56:59]
    v_mfma_f32_16x16x32_bf16 v[52:55], v[220:223], v[136:139], v[52:55]
    ds_read_b128 v[8:11], v4 offset:3232
    v_mfma_f32_16x16x32_bf16 v[52:55], v[224:227], v[140:143], v[52:55]
    s_waitcnt lgkmcnt(9)
    v_mfma_f32_16x16x32_bf16 v[52:55], v[92:95], v[20:23], v[52:55]
    v_mfma_f32_16x16x32_bf16 v[56:59], v[124:127], v[20:23], v[56:59]
    s_waitcnt lgkmcnt(8)
    v_mfma_f32_16x16x32_bf16 v[196:199], v[44:47], v[176:179], 0
    ds_read_b128 v[20:23], v4 offset:3168
    v_mfma_f32_16x16x32_bf16 v[244:247], v[44:47], v[180:183], 0
    v_mfma_f32_16x16x32_bf16 v[200:203], v[44:47], v[184:187], 0
    s_nop 1
    ds_write_b128 v5, v[52:55] offset:5120
    v_mfma_f32_16x16x32_bf16 v[56:59], v[128:131], v[44:47], v[56:59]
    s_waitcnt lgkmcnt(9)
    v_mfma_f32_16x16x32_bf16 v[248:251], v[24:27], v[180:183], 0
    ds_read_b128 v[44:47], v4 offset:3104
    v_cvt_pk_bf16_f32 v196, v196, v244
    v_cvt_pk_bf16_f32 v197, v197, v245
    s_waitcnt lgkmcnt(9)
    v_mfma_f32_16x16x32_bf16 v[56:59], v[132:135], v[12:15], v[56:59]
    ds_read_b128 v[24:27], v4 offset:3040
    v_cvt_pk_bf16_f32 v198, v198, v246
    v_cvt_pk_bf16_f32 v199, v199, v247
    v_mfma_f32_16x16x32_bf16 v[56:59], v[220:223], v[144:147], v[56:59]
    ds_read_b128 v[12:15], v4 offset:3024
    v_mfma_f32_16x16x32_bf16 v[56:59], v[224:227], v[148:151], v[56:59]
    v_cvt_pk_bf16_f32 v200, v200, v248
    v_cvt_pk_bf16_f32 v201, v201, v249
    s_waitcnt lgkmcnt(3)
    s_barrier
    v_mfma_f32_16x16x32_bf16 v[56:59], v[212:215], v[152:155], v[56:59]
    v_cvt_pk_bf16_f32 v202, v202, v250
    v_cvt_pk_bf16_f32 v203, v203, v251
    v_mfma_f32_16x16x32_bf16 v[56:59], v[216:219], v[156:159], v[56:59]
    v_mfma_f32_16x16x32_bf16 v[56:59], v[236:239], v[160:163], v[56:59]
    v_mfma_f32_16x16x32_bf16 v[56:59], v[232:235], v[164:167], v[56:59]
    v_mfma_f32_16x16x32_bf16 v[56:59], v[228:231], v[168:171], v[56:59]
    v_mfma_f32_16x16x32_bf16 v[56:59], v[64:67], v[28:31], v[56:59]
    v_mfma_f32_16x16x32_bf16 v[60:63], v[96:99], v[28:31], 0
    v_mfma_f32_16x16x32_bf16 v[56:59], v[68:71], v[40:43], v[56:59]
    ds_read_b128 v[28:31], v4 offset:2016
    v_mfma_f32_16x16x32_bf16 v[60:63], v[100:103], v[40:43], v[60:63]
    v_mfma_f32_16x16x32_bf16 v[56:59], v[72:75], v[32:35], v[56:59]
    ds_read_b128 v[40:43], v4 offset:4064
    v_mfma_f32_16x16x32_bf16 v[60:63], v[104:107], v[32:35], v[60:63]
    v_mfma_f32_16x16x32_bf16 v[56:59], v[76:79], v[16:19], v[56:59]
    ds_read_b128 v[32:35], v4 offset:4000
    v_mfma_f32_16x16x32_bf16 v[60:63], v[108:111], v[16:19], v[60:63]
    v_mfma_f32_16x16x32_bf16 v[56:59], v[80:83], v[36:39], v[56:59]
    ds_read_b128 v[16:19], v4 offset:3936
    v_mfma_f32_16x16x32_bf16 v[60:63], v[112:115], v[36:39], v[60:63]
    v_mfma_f32_16x16x32_bf16 v[56:59], v[84:87], v[8:11], v[56:59]
    ds_read_b128 v[36:39], v4 offset:3872
    v_mfma_f32_16x16x32_bf16 v[60:63], v[116:119], v[8:11], v[60:63]
    v_mfma_f32_16x16x32_bf16 v[56:59], v[88:91], v[20:23], v[56:59]
    ds_read_b128 v[8:11], v4 offset:3808
    v_mfma_f32_16x16x32_bf16 v[60:63], v[120:123], v[20:23], v[60:63]
    v_mfma_f32_16x16x32_bf16 v[56:59], v[196:199], v[136:139], v[56:59]
    ds_read_b128 v[20:23], v4 offset:3744
    v_mfma_f32_16x16x32_bf16 v[56:59], v[200:203], v[140:143], v[56:59]
    s_waitcnt lgkmcnt(9)
    v_mfma_f32_16x16x32_bf16 v[56:59], v[92:95], v[44:47], v[56:59]
    v_mfma_f32_16x16x32_bf16 v[60:63], v[124:127], v[44:47], v[60:63]
    s_waitcnt lgkmcnt(8)
    v_mfma_f32_16x16x32_bf16 v[204:207], v[24:27], v[176:179], 0
    ds_read_b128 v[44:47], v4 offset:3680
    v_mfma_f32_16x16x32_bf16 v[244:247], v[24:27], v[180:183], 0
    v_mfma_f32_16x16x32_bf16 v[208:211], v[24:27], v[184:187], 0
    s_nop 1
    ds_write_b128 v5, v[56:59] offset:6144
    v_mfma_f32_16x16x32_bf16 v[60:63], v[128:131], v[24:27], v[60:63]
    s_waitcnt lgkmcnt(9)
    v_mfma_f32_16x16x32_bf16 v[248:251], v[12:15], v[180:183], 0
    ds_read_b128 v[24:27], v4 offset:3616
    v_cvt_pk_bf16_f32 v204, v204, v244
    v_cvt_pk_bf16_f32 v205, v205, v245
    s_waitcnt lgkmcnt(9)
    v_mfma_f32_16x16x32_bf16 v[60:63], v[132:135], v[28:31], v[60:63]
    v_cvt_pk_bf16_f32 v206, v206, v246
    v_cvt_pk_bf16_f32 v207, v207, v247
    v_mfma_f32_16x16x32_bf16 v[60:63], v[196:199], v[144:147], v[60:63]
    v_mfma_f32_16x16x32_bf16 v[60:63], v[200:203], v[148:151], v[60:63]
    v_cvt_pk_bf16_f32 v208, v208, v248
    v_cvt_pk_bf16_f32 v209, v209, v249
    s_waitcnt lgkmcnt(1)
    s_barrier
    v_mfma_f32_16x16x32_bf16 v[60:63], v[220:223], v[152:155], v[60:63]
    v_cvt_pk_bf16_f32 v210, v210, v250
    v_cvt_pk_bf16_f32 v211, v211, v251
    v_mfma_f32_16x16x32_bf16 v[60:63], v[224:227], v[156:159], v[60:63]
    v_mfma_f32_16x16x32_bf16 v[60:63], v[240:243], v[160:163], v[60:63]
    v_mfma_f32_16x16x32_bf16 v[60:63], v[236:239], v[164:167], v[60:63]
    v_mfma_f32_16x16x32_bf16 v[60:63], v[232:235], v[168:171], v[60:63]
    v_mfma_f32_16x16x32_bf16 v[60:63], v[228:231], v[172:175], v[60:63]
    v_mfma_f32_16x16x32_bf16 v[60:63], v[64:67], v[40:43], v[60:63]
    v_mfma_f32_16x16x32_bf16 v[60:63], v[68:71], v[32:35], v[60:63]
    v_mfma_f32_16x16x32_bf16 v[60:63], v[72:75], v[16:19], v[60:63]
    v_mfma_f32_16x16x32_bf16 v[60:63], v[76:79], v[36:39], v[60:63]
    v_mfma_f32_16x16x32_bf16 v[60:63], v[80:83], v[8:11], v[60:63]
    v_mfma_f32_16x16x32_bf16 v[60:63], v[84:87], v[20:23], v[60:63]
    v_mfma_f32_16x16x32_bf16 v[60:63], v[204:207], v[136:139], v[60:63]
    v_mfma_f32_16x16x32_bf16 v[60:63], v[208:211], v[140:143], v[60:63]
    v_mfma_f32_16x16x32_bf16 v[60:63], v[88:91], v[44:47], v[60:63]
    s_waitcnt lgkmcnt(0)
    v_mfma_f32_16x16x32_bf16 v[60:63], v[92:95], v[24:27], v[60:63]
    s_nop 7
    ds_write_b128 v5, v[60:63] offset:7168
    s_waitcnt lgkmcnt(0)
    s_barrier
    s_endpgm
.p2align 6
L_touch_row:
    s_branch L_consts_done
L_row:
    v_subrev_u32 v2, 256, v0
    s_lshl_b32 s7, s43, 8
    s_add_u32 m0, s7, 512
    s_mov_b32 s66, 0xbf317218
    s_mov_b32 s67, 0xffff0000
    s_mov_b32 s70, 0
    ds_write_b128 v3, v[96:99]
    ds_write_b128 v3, v[100:103] offset:1024
    ds_write_b128 v3, v[104:107] offset:2048
    s_setprio 0
    s_waitcnt lgkmcnt(0)
    s_barrier
    ds_read_b128 v[196:199], v252 offset:55808
    s_mov_b64 s[76:77], 0
    s_waitcnt vmcnt(2)
    v_lshlrev_b32 v64, 16, v244
    v_and_b32 v66, s67, v244
    v_lshlrev_b32 v68, 16, v245
    v_and_b32 v70, s67, v245
    v_lshlrev_b32 v65, 16, v246
    v_and_b32 v67, s67, v246
    v_lshlrev_b32 v69, 16, v247
    v_and_b32 v71, s67, v247
    s_waitcnt lgkmcnt(0)
    v_lshlrev_b32 v72, 16, v196
    v_and_b32 v74, s67, v196
    v_lshlrev_b32 v76, 16, v197
    v_and_b32 v78, s67, v197
    v_lshlrev_b32 v73, 16, v198
    v_and_b32 v75, s67, v198
    v_lshlrev_b32 v77, 16, v199
    v_and_b32 v79, s67, v199
    s_waitcnt vmcnt(0)
L_row0_cmp:
    v_cmp_ne_u32_e64 vcc, s42, v179
    v_cmp_ne_u32 s[74:75], s42, v183
    s_nop 0
    s_or_b64 s[64:65], vcc, s[74:75]
    s_or_b64 s[64:65], s[64:65], s[76:77]
    s_cbranch_scc1 L_row0_retry
L_row0_ok:
    v_and_b32 v160, s67, v176
    v_and_b32 v161, s67, v177
    v_mul_f32 v160, s66, v160
    v_mul_f32 v161, s66, v161
    v_rcp_f32 v160, v160
    v_rcp_f32 v161, v161
    v_lshlrev_b32 v162, 16, v176
    v_lshlrev_b32 v163, 16, v177
    v_mul_f32 v162, v162, v160
    v_mul_f32 v163, v163, v161
    v_pk_fma_f32 v[112:113], v[64:65], v[160:161], v[162:163] neg_lo:[0,0,1] neg_hi:[0,0,1]
    v_pk_fma_f32 v[114:115], v[66:67], v[160:161], v[162:163] neg_lo:[0,0,1] neg_hi:[0,0,1]
    v_pk_fma_f32 v[116:117], v[68:69], v[160:161], v[162:163] neg_lo:[0,0,1] neg_hi:[0,0,1]
    v_pk_fma_f32 v[118:119], v[70:71], v[160:161], v[162:163] neg_lo:[0,0,1] neg_hi:[0,0,1]
    v_cvt_pk_bf16_f32 v164, v112, v113
    v_cvt_pk_bf16_f32 v165, v114, v115
    v_cvt_pk_bf16_f32 v166, v116, v117
    v_cvt_pk_bf16_f32 v167, v118, v119
    ds_write_addtid_b32 v164 offset:0
    ds_write_addtid_b32 v165 offset:4608
    ds_write_addtid_b32 v166 offset:9216
    ds_write_addtid_b32 v167 offset:13824
    v_and_b32 v160, s67, v180
    v_and_b32 v161, s67, v181
    v_mul_f32 v160, s66, v160
    v_mul_f32 v161, s66, v161
    v_rcp_f32 v160, v160
    v_rcp_f32 v161, v161
    v_lshlrev_b32 v162, 16, v180
    v_lshlrev_b32 v163, 16, v181
    v_mul_f32 v162, v162, v160
    v_mul_f32 v163, v163, v161
    v_pk_fma_f32 v[120:121], v[72:73], v[160:161], v[162:163] neg_lo:[0,0,1] neg_hi:[0,0,1]
    v_pk_fma_f32 v[122:123], v[74:75], v[160:161], v[162:163] neg_lo:[0,0,1] neg_hi:[0,0,1]
    v_pk_fma_f32 v[124:125], v[76:77], v[160:161], v[162:163] neg_lo:[0,0,1] neg_hi:[0,0,1]
    v_pk_fma_f32 v[126:127], v[78:79], v[160:161], v[162:163] neg_lo:[0,0,1] neg_hi:[0,0,1]
    v_cvt_pk_bf16_f32 v164, v120, v121
    v_cvt_pk_bf16_f32 v165, v122, v123
    v_cvt_pk_bf16_f32 v166, v124, v125
    v_cvt_pk_bf16_f32 v167, v126, v127
    ds_write_addtid_b32 v164 offset:1024
    ds_write_addtid_b32 v165 offset:5632
    ds_write_addtid_b32 v166 offset:10240
    ds_write_addtid_b32 v167 offset:14848
    v_exp_f32 v144, v112
    v_exp_f32 v145, v113
    v_exp_f32 v146, v114
    v_exp_f32 v147, v115
    v_exp_f32 v148, v116
    v_exp_f32 v149, v117
    v_exp_f32 v150, v118
    v_exp_f32 v151, v119
    v_pk_add_f32 v[144:145], v[144:145], 1.0 op_sel_hi:[1,0]
    v_pk_add_f32 v[146:147], v[146:147], 1.0 op_sel_hi:[1,0]
    v_pk_add_f32 v[148:149], v[148:149], 1.0 op_sel_hi:[1,0]
    v_pk_add_f32 v[150:151], v[150:151], 1.0 op_sel_hi:[1,0]
    v_rcp_f32 v144, v144
    v_rcp_f32 v145, v145
    v_rcp_f32 v146, v146
    v_rcp_f32 v147, v147
    v_rcp_f32 v148, v148
    v_rcp_f32 v149, v149
    v_rcp_f32 v150, v150
    v_rcp_f32 v151, v151
    v_pk_mul_f32 v[112:113], v[112:113], v[144:145]
    v_pk_mul_f32 v[114:115], v[114:115], v[146:147]
    v_pk_mul_f32 v[116:117], v[116:117], v[148:149]
    v_pk_mul_f32 v[118:119], v[118:119], v[150:151]
    s_waitcnt lgkmcnt(0)
    s_barrier
    global_load_dwordx4 v[184:187], v239, s[40:41] offset:-4096 sc1
    global_load_dwordx4 v[188:191], v239, s[40:41] offset:0 sc1
    global_load_dwordx2 v[248:249], v254, s[8:9] offset:0
    global_load_dwordx2 v[250:251], v254, s[8:9] offset:1024
    ds_write_b128 v252, v[244:247] offset:51712
    v_lshlrev_b32 v6, 3, v2
    v_and_b32 v8, 48, v2
    v_xor_b32_e64 v6, v6, v8
    v_add_u32 v6, 106240, v6
    v_add_u32 v241, 0x80000, v240
    v_add_u32 v242, 0x100000, v240
    v_add_u32 v243, 0x180000, v240
    v_exp_f32 v144, v120
    v_exp_f32 v145, v121
    v_exp_f32 v146, v122
    v_exp_f32 v147, v123
    v_exp_f32 v148, v124
    v_exp_f32 v149, v125
    v_exp_f32 v150, v126
    v_exp_f32 v151, v127
    v_add_f32 v144, 1.0, v144
    v_add_f32 v145, 1.0, v145
    v_add_f32 v146, 1.0, v146
    v_add_f32 v147, 1.0, v147
    v_add_f32 v148, 1.0, v148
    v_add_f32 v149, 1.0, v149
    v_add_f32 v150, 1.0, v150
    v_add_f32 v151, 1.0, v151
    v_rcp_f32 v144, v144
    v_rcp_f32 v145, v145
    v_rcp_f32 v146, v146
    v_rcp_f32 v147, v147
    v_rcp_f32 v148, v148
    v_rcp_f32 v149, v149
    v_rcp_f32 v150, v150
    v_rcp_f32 v151, v151
    v_mul_f32 v120, v120, v144
    v_mul_f32 v121, v121, v145
    v_mul_f32 v122, v122, v146
    v_mul_f32 v123, v123, v147
    v_mul_f32 v124, v124, v148
    v_mul_f32 v125, v125, v149
    v_mul_f32 v126, v126, v150
    v_mul_f32 v127, v127, v151
    s_cmp_lt_u32 s3, 6
    s_waitcnt lgkmcnt(0)
    s_barrier
    s_cbranch_scc1 L_even1
    s_waitcnt vmcnt(0)
    s_branch L_odd0
L_even1:
    ds_read_b64 v[8:9], v6 offset:0
    ds_read_b64 v[10:11], v6 offset:8192
    ds_read_b64 v[12:13], v6 offset:16384
    ds_read_b64 v[14:15], v6 offset:24576
    s_waitcnt lgkmcnt(0)
    v_fmac_f32 v64, v8, v112
    v_fmac_f32 v66, v10, v114
    v_fmac_f32 v68, v12, v116
    v_fmac_f32_e64 v70, v14, v118
    v_cvt_pk_bf16_f32 v24, v64, v66
    v_cvt_pk_bf16_f32 v25, v68, v70
    global_store_dwordx2 v240, v[24:25], s[36:37] offset:0
    v_fmac_f32 v65, v9, v113
    v_fmac_f32 v67, v11, v115
    v_fmac_f32 v69, v13, v117
    v_fmac_f32 v71, v15, v119
    v_cvt_pk_bf16_f32 v26, v65, v67
    v_cvt_pk_bf16_f32 v27, v69, v71
    global_store_dwordx2 v240, v[26:27], s[36:37] offset:1024
L_odd0:
    s_waitcnt vmcnt(2)
L_row_cmp:
    v_cmp_ne_u32 vcc, s42, v187
    v_cmp_ne_u32 s[74:75], s42, v191
    s_nop 0
    s_or_b64 s[64:65], vcc, s[74:75]
    s_or_b64 s[64:65], s[64:65], s[76:77]
    s_cbranch_scc1 L_row_retry
L_row_ok:
    ds_write_b128 v252, v[248:251] offset:59904
    s_cmp_lt_u32 s3, 6
    v_lshlrev_b32 v80, 16, v248
    v_and_b32 v82, s67, v248
    v_lshlrev_b32 v84, 16, v249
    v_and_b32 v86, s67, v249
    v_lshlrev_b32 v81, 16, v250
    v_and_b32 v83, s67, v250
    v_lshlrev_b32 v85, 16, v251
    v_and_b32 v87, s67, v251
    v_and_b32 v160, s67, v184
    v_and_b32 v161, s67, v185
    v_mul_f32 v160, s66, v160
    v_mul_f32 v161, s66, v161
    v_rcp_f32 v160, v160
    v_rcp_f32 v161, v161
    v_lshlrev_b32 v162, 16, v184
    v_lshlrev_b32 v163, 16, v185
    v_mul_f32 v162, v162, v160
    v_mul_f32_e64 v163, v163, v161
    v_fma_f32 v128, v80, v160, -v162
    v_fma_f32 v129, v81, v161, -v163
    v_fma_f32 v130, v82, v160, -v162
    v_fma_f32 v131, v83, v161, -v163
    v_fma_f32 v132, v84, v160, -v162
    v_fma_f32 v133, v85, v161, -v163
    v_fma_f32 v134, v86, v160, -v162
    v_fma_f32 v135, v87, v161, -v163
    v_cvt_pk_bf16_f32 v164, v128, v129
    v_cvt_pk_bf16_f32 v165, v130, v131
    v_cvt_pk_bf16_f32 v166, v132, v133
    v_cvt_pk_bf16_f32 v167, v134, v135
    ds_write_addtid_b32 v164 offset:2048
    ds_write_addtid_b32 v165 offset:6656
    ds_write_addtid_b32 v166 offset:11264
    ds_write_addtid_b32 v167 offset:15872
    s_cbranch_scc1 L_even0
    s_waitcnt lgkmcnt(0)
    s_barrier
    ds_read_b64 v[8:9], v6 offset:0
    ds_read_b64 v[10:11], v6 offset:8192
    ds_read_b64 v[12:13], v6 offset:16384
    ds_read_b64 v[14:15], v6 offset:24576
    s_waitcnt lgkmcnt(0)
    v_fmac_f32 v64, v8, v112
    v_fmac_f32 v66, v10, v114
    v_fmac_f32 v68, v12, v116
    v_fmac_f32 v70, v14, v118
    v_cvt_pk_bf16_f32 v24, v64, v66
    v_cvt_pk_bf16_f32 v25, v68, v70
    global_store_dwordx2 v240, v[24:25], s[36:37] offset:0
    v_fmac_f32 v65, v9, v113
    v_fmac_f32 v67, v11, v115
    v_fmac_f32 v69, v13, v117
    v_fmac_f32 v71, v15, v119
    v_cvt_pk_bf16_f32 v26, v65, v67
    v_cvt_pk_bf16_f32 v27, v69, v71
    global_store_dwordx2 v240, v[26:27], s[36:37] offset:1024
L_even0:
    s_waitcnt lgkmcnt(0)
    s_barrier
    v_exp_f32 v144, v128
    v_exp_f32 v145, v129
    v_exp_f32 v146, v130
    v_exp_f32 v147, v131
    v_exp_f32 v148, v132
    v_exp_f32 v149, v133
    v_exp_f32 v150, v134
    v_exp_f32 v151, v135
    v_add_f32 v144, 1.0, v144
    v_add_f32 v145, 1.0, v145
    v_add_f32 v146, 1.0, v146
    v_add_f32 v147, 1.0, v147
    v_add_f32 v148, 1.0, v148
    v_add_f32 v149, 1.0, v149
    v_add_f32 v150, 1.0, v150
    v_add_f32 v151, 1.0, v151
    v_rcp_f32 v144, v144
    v_rcp_f32 v145, v145
    v_rcp_f32 v146, v146
    v_rcp_f32 v147, v147
    v_rcp_f32 v148, v148
    v_rcp_f32 v149, v149
    v_rcp_f32 v150, v150
    v_rcp_f32 v151, v151
    v_mul_f32 v128, v128, v144
    v_mul_f32 v129, v129, v145
    v_mul_f32 v130, v130, v146
    v_mul_f32 v131, v131, v147
    v_mul_f32 v132, v132, v148
    v_mul_f32 v133, v133, v149
    v_mul_f32 v134, v134, v150
    v_mul_f32 v135, v135, v151
    s_waitcnt lgkmcnt(0)
    s_barrier
    ds_read_b64 v[8:9], v6 offset:2048
    ds_read_b64 v[10:11], v6 offset:10240
    ds_read_b64 v[12:13], v6 offset:18432
    ds_read_b64 v[14:15], v6 offset:26624
    s_waitcnt lgkmcnt(0)
    v_fmac_f32 v72, v8, v120
    v_fmac_f32 v74, v10, v122
    v_fmac_f32 v76, v12, v124
    v_fmac_f32_e64 v78, v14, v126
    v_cvt_pk_bf16_f32 v28, v72, v74
    v_cvt_pk_bf16_f32 v29, v76, v78
    global_store_dwordx2 v241, v[28:29], s[36:37] offset:0
    v_fmac_f32 v73, v9, v121
    v_fmac_f32 v75, v11, v123
    v_fmac_f32 v77, v13, v125
    v_fmac_f32 v79, v15, v127
    v_cvt_pk_bf16_f32 v30, v73, v75
    v_cvt_pk_bf16_f32 v31, v77, v79
    global_store_dwordx2 v241, v[30:31], s[36:37] offset:1024
    s_waitcnt lgkmcnt(0)
    s_barrier
    ds_read_b128 v[196:199], v252 offset:64000
    s_waitcnt lgkmcnt(0)
    v_lshlrev_b32 v88, 16, v196
    v_and_b32 v90, s67, v196
    v_lshlrev_b32 v92, 16, v197
    v_and_b32 v94, s67, v197
    v_lshlrev_b32 v89, 16, v198
    v_and_b32 v91, s67, v198
    v_lshlrev_b32 v93, 16, v199
    v_and_b32 v95, s67, v199
    v_and_b32 v160, s67, v188
    v_and_b32 v161, s67, v189
    v_mul_f32 v160, s66, v160
    v_mul_f32 v161, s66, v161
    v_rcp_f32 v160, v160
    v_rcp_f32 v161, v161
    v_lshlrev_b32 v162, 16, v188
    v_lshlrev_b32 v163, 16, v189
    v_mul_f32 v162, v162, v160
    v_mul_f32_e64 v163, v163, v161
    v_fma_f32 v136, v88, v160, -v162
    v_fma_f32 v137, v89, v161, -v163
    v_fma_f32 v138, v90, v160, -v162
    v_fma_f32 v139, v91, v161, -v163
    v_fma_f32 v140, v92, v160, -v162
    v_fma_f32 v141, v93, v161, -v163
    v_fma_f32 v142, v94, v160, -v162
    v_fma_f32 v143, v95, v161, -v163
    v_cvt_pk_bf16_f32 v164, v136, v137
    v_cvt_pk_bf16_f32 v165, v138, v139
    v_cvt_pk_bf16_f32 v166, v140, v141
    v_cvt_pk_bf16_f32 v167, v142, v143
    ds_write_addtid_b32 v164 offset:3072
    ds_write_addtid_b32 v165 offset:7680
    ds_write_addtid_b32 v166 offset:12288
    ds_write_addtid_b32 v167 offset:16896
    s_waitcnt lgkmcnt(0)
    s_barrier
    ds_read_b64 v[8:9], v6 offset:4096
    ds_read_b64 v[10:11], v6 offset:12288
    ds_read_b64 v[12:13], v6 offset:20480
    ds_read_b64 v[14:15], v6 offset:28672
    s_waitcnt lgkmcnt(0)
    v_fmac_f32 v80, v8, v128
    v_fmac_f32 v82, v10, v130
    v_fmac_f32 v84, v12, v132
    v_fmac_f32_e64 v86, v14, v134
    v_cvt_pk_bf16_f32 v32, v80, v82
    v_cvt_pk_bf16_f32 v33, v84, v86
    global_store_dwordx2 v242, v[32:33], s[36:37] offset:0
    v_fmac_f32 v81, v9, v129
    v_fmac_f32 v83, v11, v131
    v_fmac_f32 v85, v13, v133
    v_fmac_f32 v87, v15, v135
    v_cvt_pk_bf16_f32 v34, v81, v83
    v_cvt_pk_bf16_f32 v35, v85, v87
    global_store_dwordx2 v242, v[34:35], s[36:37] offset:1024
    s_cmp_eq_u32 s3, 4
    s_cbranch_scc1 L_fix
    s_waitcnt lgkmcnt(0)
    s_barrier
    s_cmp_lt_u32 s3, 6
    v_exp_f32 v144, v136
    v_exp_f32 v145, v137
    v_exp_f32 v146, v138
    v_exp_f32 v147, v139
    v_exp_f32 v148, v140
    v_exp_f32 v149, v141
    v_exp_f32 v150, v142
    v_exp_f32 v151, v143
    v_add_f32 v144, 1.0, v144
    v_add_f32 v145, 1.0, v145
    v_add_f32 v146, 1.0, v146
    v_add_f32 v147, 1.0, v147
    v_add_f32 v148, 1.0, v148
    v_add_f32 v149, 1.0, v149
    v_add_f32 v150, 1.0, v150
    v_add_f32 v151, 1.0, v151
    v_rcp_f32 v144, v144
    v_rcp_f32 v145, v145
    v_rcp_f32 v146, v146
    v_rcp_f32 v147, v147
    v_rcp_f32 v148, v148
    v_rcp_f32 v149, v149
    v_rcp_f32 v150, v150
    v_rcp_f32 v151, v151
    v_mul_f32 v136, v136, v144
    v_mul_f32 v137, v137, v145
    v_mul_f32 v138, v138, v146
    v_mul_f32 v139, v139, v147
    v_mul_f32 v140, v140, v148
    v_mul_f32 v141, v141, v149
    v_mul_f32 v142, v142, v150
    v_mul_f32_e64 v143, v143, v151
    s_waitcnt lgkmcnt(0)
    s_barrier
    ds_read_b64 v[8:9], v6 offset:6144
    ds_read_b64 v[10:11], v6 offset:14336
    ds_read_b64 v[12:13], v6 offset:22528
    ds_read_b64 v[14:15], v6 offset:30720
    s_waitcnt lgkmcnt(0)
    v_fmac_f32 v88, v8, v136
    v_fmac_f32 v90, v10, v138
    v_fmac_f32 v92, v12, v140
    v_fmac_f32_e64 v94, v14, v142
    v_cvt_pk_bf16_f32 v36, v88, v90
    v_cvt_pk_bf16_f32 v37, v92, v94
    global_store_dwordx2 v243, v[36:37], s[36:37] offset:0
    v_fmac_f32 v89, v9, v137
    v_fmac_f32 v91, v11, v139
    v_fmac_f32 v93, v13, v141
    v_fmac_f32 v95, v15, v143
    v_cvt_pk_bf16_f32 v38, v89, v91
    v_cvt_pk_bf16_f32 v39, v93, v95
    global_store_dwordx2 v243, v[38:39], s[36:37] offset:1024
    s_cbranch_scc0 L_odd
    s_barrier
L_odd:
    s_barrier
    s_endpgm
L_row0_retry:
    s_add_u32 s70, s70, 1
    s_cmp_ge_u32 s70, 1000000
    s_cbranch_scc1 L_row0_ok
    s_and_b32 s7, s70, 15
    s_cbranch_scc1 L_row0_repoll
    v_mov_b32_e64 v8, 0
    global_load_dword v9, v8, s[38:39] sc0 sc1
    s_waitcnt vmcnt(0)
    v_readfirstlane_b32 s7, v9
    s_nop 0
    s_cmp_lg_u32 s7, 0
    s_cselect_b32 s42, s7, s42
L_row0_repoll:
    s_sleep 1
    s_mov_b64 exec, vcc
    s_cbranch_execz L_row0_s0
    global_load_dwordx4 v[176:179], v238, s[40:41] offset:-4096 sc1
L_row0_s0:
    s_mov_b64 exec, s[74:75]
    s_cbranch_execz L_row0_s1
    global_load_dwordx4 v[180:183], v238, s[40:41] offset:0 sc1
L_row0_s1:
    s_mov_b64 exec, -1
    s_waitcnt vmcnt(0)
    s_branch L_row0_cmp
L_row_retry:
    s_add_u32 s70, s70, 1
    s_cmp_ge_u32 s70, 1000000
    s_cbranch_scc1 L_row_ok
    s_sleep 1
    s_mov_b64 exec, vcc
    s_cbranch_execz L_row_s0
    global_load_dwordx4 v[184:187], v239, s[40:41] offset:-4096 sc1
L_row_s0:
    s_mov_b64 exec, s[74:75]
    s_cbranch_execz L_row_s1
    global_load_dwordx4 v[188:191], v239, s[40:41] offset:0 sc1
L_row_s1:
    s_mov_b64 exec, -1
    s_waitcnt vmcnt(0)
    s_branch L_row_cmp
L_fix:
    s_lshl_b32 s7, s4, 12
    s_add_u32 s7, s7, 65536
    v_lshl_add_u32 v4, v1, 4, s7
    v_mov_b32 v212, 0
    v_mov_b32 v213, 0
    v_mov_b32 v215, s42
    s_mov_b32 s70, 0
    v_and_b32 v5, 1, v1
    v_lshlrev_b32 v5, 4, v5
    v_lshlrev_b32 v5, v5, 1
    v_mul_u32_u24 v5, 0x3f80, v5
    v_bfe_i32 v7, v1, 1, 1
    v_and_b32 v217, v7, v5
    v_mov_b32 v44, 0
    v_mov_b32 v45, 0
    v_mov_b32 v46, 0
    v_mov_b32 v47, 0
    v_xor_b32_e64 v216, v217, v5
    s_barrier
    global_load_dwordx4 v[200:203], v4, s[40:41] offset:0 sc1
    global_load_dwordx4 v[204:207], v4, s[40:41] offset:1024 sc1
    global_load_dwordx4 v[208:211], v4, s[40:41] offset:2048 sc1
    s_mov_b32 exec_hi, 0
    global_load_dwordx4 v[212:215], v4, s[40:41] offset:3072 sc1
    s_mov_b64 exec, -1
    v_exp_f32 v144, v136
    v_exp_f32 v145, v137
    v_exp_f32 v146, v138
    v_exp_f32 v147, v139
    v_exp_f32 v148, v140
    v_exp_f32 v149, v141
    v_exp_f32 v150, v142
    v_exp_f32 v151, v143
    v_add_f32 v144, 1.0, v144
    v_add_f32 v145, 1.0, v145
    v_add_f32 v146, 1.0, v146
    v_add_f32 v147, 1.0, v147
    v_add_f32 v148, 1.0, v148
    v_add_f32 v149, 1.0, v149
    v_add_f32 v150, 1.0, v150
    v_add_f32 v151, 1.0, v151
    v_rcp_f32 v144, v144
    v_rcp_f32 v145, v145
    v_rcp_f32 v146, v146
    v_rcp_f32 v147, v147
    v_rcp_f32 v148, v148
    v_rcp_f32 v149, v149
    v_rcp_f32 v150, v150
    v_rcp_f32 v151, v151
    v_mul_f32 v136, v136, v144
    v_mul_f32 v137, v137, v145
    v_mul_f32 v138, v138, v146
    v_mul_f32 v139, v139, v147
    v_mul_f32 v140, v140, v148
    v_mul_f32 v141, v141, v149
    v_mul_f32 v142, v142, v150
    v_mul_f32_e64 v143, v143, v151
    s_barrier
    ds_read_b64 v[8:9], v6 offset:6144
    ds_read_b64 v[10:11], v6 offset:14336
    ds_read_b64 v[12:13], v6 offset:22528
    ds_read_b64 v[14:15], v6 offset:30720
    s_waitcnt lgkmcnt(0)
    v_fmac_f32 v88, v8, v136
    v_fmac_f32 v90, v10, v138
    v_fmac_f32 v92, v12, v140
    v_fmac_f32_e64 v94, v14, v142
    v_cvt_pk_bf16_f32 v36, v88, v90
    v_cvt_pk_bf16_f32 v37, v92, v94
    global_store_dwordx2 v243, v[36:37], s[36:37] offset:0
    v_fmac_f32 v89, v9, v137
    v_fmac_f32 v91, v11, v139
    v_fmac_f32 v93, v13, v141
    v_fmac_f32 v95, v15, v143
    v_cvt_pk_bf16_f32 v38, v89, v91
    v_cvt_pk_bf16_f32 v39, v93, v95
    global_store_dwordx2 v243, v[38:39], s[36:37] offset:1024
    s_mov_b32 s71, 0
    s_waitcnt vmcnt(2)
L_inbox_cmp:
    v_cmp_ne_u32_e64 vcc, s42, v203
    v_cmp_ne_u32 s[74:75], s42, v207
    v_cmp_ne_u32 s[76:77], s42, v211
    v_cmp_ne_u32 s[78:79], s42, v215
    s_or_b64 s[64:65], vcc, s[74:75]
    s_or_b64 s[64:65], s[64:65], s[78:79]
    s_or_b64 s[64:65], s[64:65], s[76:77]
    s_cbranch_scc1 L_inbox_retry
L_inbox_ok:
    s_cmp_lg_u32 s71, 0
    s_cbranch_scc1 L_y7_1
    s_mov_b32 s71, 1
    s_barrier
L_y7_1:
    v_mfma_f32_16x16x16_bf16 v[52:55], v[216:217], v[200:201], 0
    v_mfma_f32_16x16x16_bf16 v[52:55], v[216:217], v[204:205], v[52:55]
    v_mfma_f32_16x16x16_bf16 v[52:55], v[216:217], v[208:209], v[52:55]
    v_mfma_f32_16x16x16_bf16 v[52:55], v[216:217], v[212:213], v[52:55]
    v_and_b32 v10, 0x7ff, v202
    v_lshlrev_b32 v24, 3, v10
    v_lshlrev_b32 v27, 1, v10
    v_lshlrev_b32 v25, 2, v10
    v_lshrrev_b32 v26, 1, v10
    v_and_b32 v26, 48, v26
    v_xor_b32 v25, v25, v26
    v_add_u32 v25, 106240, v25
    ds_read_u16_d16_hi v44, v27 offset:512
    ds_read_u16_d16_hi v45, v27 offset:5120
    ds_read_u16_d16_hi v46, v27 offset:9728
    ds_read_u16_d16_hi v47, v27 offset:14336
    ds_read_b64 v[40:41], v24 offset:51712
    ds_read_b32 v48, v25 offset:0
    ds_read_b32 v49, v25 offset:8192
    ds_read_b32 v50, v25 offset:16384
    ds_read_b32 v51, v25 offset:24576
    v_add_f32_dpp v52, v52, v52 row_ror:8 row_mask:0xf bank_mask:0xf
    v_add_f32_dpp v53, v53, v53 row_ror:8 row_mask:0xf bank_mask:0xf
    v_add_f32_dpp v54, v54, v54 row_ror:8 row_mask:0xf bank_mask:0xf
    v_add_f32_dpp v55, v55, v55 row_ror:8 row_mask:0xf bank_mask:0xf
    v_add_f32_dpp v52, v52, v52 row_ror:4 row_mask:0xf bank_mask:0xf
    v_add_f32_dpp v53, v53, v53 row_ror:4 row_mask:0xf bank_mask:0xf
    v_add_f32_dpp v54, v54, v54 row_ror:4 row_mask:0xf bank_mask:0xf
    v_add_f32_dpp v55, v55, v55 row_ror:4 row_mask:0xf bank_mask:0xf
    v_add_f32_dpp v52, v52, v52 row_ror:2 row_mask:0xf bank_mask:0xf
    v_add_f32_dpp v53, v53, v53 row_ror:2 row_mask:0xf bank_mask:0xf
    v_add_f32_dpp v54, v54, v54 row_ror:2 row_mask:0xf bank_mask:0xf
    v_add_f32_dpp v55, v55, v55 row_ror:2 row_mask:0xf bank_mask:0xf
    s_lshl_b32 s7, s4, 3
    v_lshl_add_u32 v24, v10, 10, s7
    s_waitcnt lgkmcnt(5)
    v_add_f32 v52, v52, v44
    v_add_f32 v53, v53, v45
    v_add_f32 v54, v54, v46
    v_add_f32 v55, v55, v47
    v_exp_f32 v56, v52
    v_exp_f32 v57, v53
    v_exp_f32 v58, v54
    v_exp_f32 v59, v55
    s_waitcnt lgkmcnt(0)
    v_lshlrev_b32 v60, 16, v40
    v_and_b32 v61, s67, v40
    v_lshlrev_b32 v62, 16, v41
    v_and_b32 v63, s67, v41
    v_add_f32 v56, 1.0, v56
    v_add_f32 v57, 1.0, v57
    v_add_f32 v58, 1.0, v58
    v_add_f32 v59, 1.0, v59
    v_rcp_f32 v56, v56
    v_rcp_f32 v57, v57
    v_rcp_f32 v58, v58
    v_rcp_f32 v59, v59
    v_mul_f32 v52, v52, v56
    v_mul_f32 v53, v53, v57
    v_mul_f32 v54, v54, v58
    v_mul_f32 v55, v55, v59
    v_fmac_f32 v60, v52, v48
    v_fmac_f32 v61, v53, v49
    v_fmac_f32 v62, v54, v50
    v_fmac_f32_e64 v63, v55, v51
    v_cvt_pk_bf16_f32 v60, v60, v61
    v_cvt_pk_bf16_f32 v61, v62, v63
    s_barrier
    s_mov_b64 exec, 3
    global_store_dwordx2 v24, v[60:61], s[36:37]
    s_endpgm
L_inbox_retry:
    s_add_u32 s70, s70, 1
    s_cmp_ge_u32 s70, 1000000
    s_cbranch_scc1 L_inbox_ok
    s_mov_b64 exec, vcc
    s_cbranch_execz L_inbox_s0
    global_load_dwordx4 v[200:203], v4, s[40:41] offset:0 sc1
L_inbox_s0:
    s_mov_b64 exec, s[74:75]
    s_cbranch_execz L_inbox_s1
    global_load_dwordx4 v[204:207], v4, s[40:41] offset:1024 sc1
L_inbox_s1:
    s_mov_b64 exec, s[76:77]
    s_cbranch_execz L_inbox_s2
    global_load_dwordx4 v[208:211], v4, s[40:41] offset:2048 sc1
L_inbox_s2:
    s_mov_b64 exec, s[78:79]
    s_cbranch_execz L_inbox_s3
    global_load_dwordx4 v[212:215], v4, s[40:41] offset:3072 sc1
L_inbox_s3:
    s_mov_b64 exec, -1
    s_cmp_lg_u32 s71, 0
    s_cbranch_scc1 L_y7_0
    s_mov_b32 s71, 1
    s_barrier
L_y7_0:
    s_waitcnt vmcnt(0)
    s_branch L_inbox_cmp
.p2align 6
L_aux:
    s_lshr_b32 s43, s6, 1
    s_mul_i32 s43, s43, 28
    s_and_b32 s7, s6, 1
    s_lshl_b32 s7, s7, 4
    s_add_u32 s7, s7, s5
    s_add_u32 s43, s43, s7
    s_mov_b32 s5, s7
    s_mov_b32 s72, 0x3f803f80
    v_add_u32 v2, 8192, v2
    v_add_u32 v3, 8192, v2
    v_lshlrev_b32 v4, 1, v0
    v_lshrrev_b32_e64 v49, 1, v0
    v_and_b32 v49, 0x78, v49
    ds_write_b64 v49, v[40:41] offset:0
    v_sub_u32 v52, 4095, v4
    v_sub_u32 v53, 4094, v4
    v_sub_u32 v54, 3583, v4
    v_sub_u32 v55, 3582, v4
    v_sub_u32 v56, 3071, v4
    v_sub_u32 v57, 3070, v4
    v_sub_u32 v58, 2559, v4
    v_sub_u32 v59, 2558, v4
    v_and_b32 v7, 15, v0
    v_and_b32 v50, 48, v1
    v_and_b32_e64 v51, 1, v0
    s_mul_i32 s73, s3, 12288
    s_add_u32 s73, s73, 16384
    v_lshlrev_b32_e64 v60, 3, v7
    v_lshl_add_u32 v61, v50, 4, v60
    v_add_u32 v61, s73, v61
    v_lshrrev_b32 v5, 2, v1
    v_and_b32 v4, 3, v1
    v_lshlrev_b32 v4, 3, v4
    v_lshl_add_u32 v4, v5, 8, v4
    v_and_b32_e64 v5, 7, v5
    v_lshl_add_u32 v4, v5, 5, v4
    v_add_u32 v168, s73, v4
    v_xor_b32 v169, 32, v168
    v_xor_b32_e64 v170, 64, v168
    v_xor_b32 v171, 0x60, v168
    v_xor_b32 v172, 0x80, v168
    v_xor_b32 v173, 0xa0, v168
    v_xor_b32 v174, 0xc0, v168
    v_xor_b32 v175, 0xe0, v168
    s_lshl_b32 s7, s3, 8
    v_add_u32 v63, s7, v50
    v_lshlrev_b32 v4, 1, v50
    v_and_b32 v5, 3, v0
    v_lshl_add_u32 v4, v5, 7, v4
    s_mul_i32 s7, s3, 528
    v_add_u32_e64 v160, s7, v4
    v_bfe_u32 v5, v0, 2, 2
    v_mul_u32_u24 v5, 528, v5
    v_add_u32 v161, v5, v4
    s_lshl_b32 s7, s3, 17
    s_lshl_b32 s73, s43, 5
    s_add_u32 s7, s7, s73
    s_add_u32 s7, s7, 65536
    v_lshlrev_b32_e64 v4, 8, v50
    v_lshl_add_u32 v4, v51, 4, v4
    v_bfe_u32 v5, v0, 1, 3
    v_lshl_add_u32 v4, v5, 14, v4
    v_add_u32 v162, s7, v4
    v_lshlrev_b32 v163, 3, v0
    v_lshlrev_b32 v5, v5, 1
    v_bfe_i32 v136, v5, 0, 1
    v_bfe_i32 v137, v5, 1, 1
    v_bfe_i32 v138, v5, 2, 1
    v_bfe_i32 v139, v5, 3, 1
    v_bfe_i32 v140, v5, 4, 1
    v_bfe_i32 v141, v5, 5, 1
    v_bfe_i32 v142, v5, 6, 1
    v_bfe_i32 v143, v5, 7, 1
    v_mov_b32 v144, s72
    v_mov_b32 v145, s72
    v_mov_b32 v146, s72
    v_mov_b32 v147, s72
    v_mov_b32 v148, s72
    v_mov_b32 v149, s72
    v_mov_b32 v150, s72
    v_mov_b32 v151, s72
    v_mov_b32 v152, s72
    v_mov_b32 v153, s72
    v_mov_b32 v154, s72
    v_mov_b32 v155, s72
    v_mov_b32 v156, s72
    v_mov_b32 v157, s72
    v_mov_b32 v158, s72
    v_mov_b32 v159, s72
    s_waitcnt vmcnt(5)
    v_dot2c_f32_bf16 v43, s72, v24
    v_dot2c_f32_bf16 v43, s72, v25
    v_dot2c_f32_bf16 v43, s72, v26
    v_dot2c_f32_bf16 v43, s72, v27
    v_dot2c_f32_bf16 v43, s72, v28
    v_dot2c_f32_bf16 v43, s72, v29
    v_dot2c_f32_bf16 v43, s72, v30
    v_dot2c_f32_bf16 v43, s72, v31
    v_dot2c_f32_bf16 v43, s72, v32
    v_dot2c_f32_bf16 v43, s72, v33
    v_dot2c_f32_bf16 v43, s72, v34
    v_dot2c_f32_bf16 v43, s72, v35
    v_dot2c_f32_bf16 v43, s72, v36
    v_dot2c_f32_bf16 v43, s72, v37
    v_dot2c_f32_bf16 v43, s72, v38
    v_dot2c_f32_bf16 v43, s72, v39
    s_nop 2
    v_add_f32_dpp v43, v43, v43 row_ror:8 row_mask:0xf bank_mask:0xf
    s_nop 1
    v_add_f32_dpp v43, v43, v43 row_ror:4 row_mask:0xf bank_mask:0xf
    s_nop 1
    v_add_f32_dpp v43, v43, v43 row_ror:2 row_mask:0xf bank_mask:0xf
    s_nop 1
    v_add_f32_dpp v43, v43, v43 row_ror:1 row_mask:0xf bank_mask:0xf
    s_mov_b32 s73, 0x3b000000
    s_waitcnt lgkmcnt(0)
    s_or_b32 s42, s42, 1
    s_add_u32 s42, s42, 0x9e3779b8
    v_mov_b32_e64 v47, s42
    s_waitcnt vmcnt(4)
    v_dot2c_f32_bf16 v40, s72, v8
    v_dot2c_f32_bf16 v41, v8, v8
    v_dot2c_f32_bf16 v42, v8, v24
    v_dot2c_f32_bf16 v40, s72, v9
    v_dot2c_f32_bf16 v41, v9, v9
    v_dot2c_f32_bf16 v42, v9, v25
    v_dot2c_f32_bf16 v40, s72, v10
    v_dot2c_f32_bf16 v41, v10, v10
    v_dot2c_f32_bf16 v42, v10, v26
    v_dot2c_f32_bf16 v40, s72, v11
    v_dot2c_f32_bf16 v41, v11, v11
    v_dot2c_f32_bf16 v42, v11, v27
    s_waitcnt vmcnt(3)
    v_dot2c_f32_bf16 v40, s72, v12
    v_dot2c_f32_bf16 v41, v12, v12
    v_dot2c_f32_bf16 v42, v12, v28
    v_dot2c_f32_bf16 v40, s72, v13
    v_dot2c_f32_bf16 v41, v13, v13
    v_dot2c_f32_bf16 v42, v13, v29
    v_dot2c_f32_bf16 v40, s72, v14
    v_dot2c_f32_bf16 v41, v14, v14
    v_dot2c_f32_bf16 v42, v14, v30
    v_dot2c_f32_bf16 v40, s72, v15
    v_dot2c_f32_bf16 v41, v15, v15
    v_dot2c_f32_bf16 v42, v15, v31
    s_waitcnt vmcnt(2)
    v_dot2c_f32_bf16 v40, s72, v16
    v_dot2c_f32_bf16 v41, v16, v16
    v_dot2c_f32_bf16 v42, v16, v32
    v_dot2c_f32_bf16 v40, s72, v17
    v_dot2c_f32_bf16 v41, v17, v17
    v_dot2c_f32_bf16 v42, v17, v33
    v_dot2c_f32_bf16 v40, s72, v18
    v_dot2c_f32_bf16 v41, v18, v18
    v_dot2c_f32_bf16 v42, v18, v34
    v_dot2c_f32_bf16 v40, s72, v19
    v_dot2c_f32_bf16 v41, v19, v19
    v_dot2c_f32_bf16 v42, v19, v35
    s_waitcnt vmcnt(1)
    v_dot2c_f32_bf16 v40, s72, v20
    v_dot2c_f32_bf16 v41, v20, v20
    v_dot2c_f32_bf16 v42, v20, v36
    v_dot2c_f32_bf16 v40, s72, v21
    v_dot2c_f32_bf16 v41, v21, v21
    v_dot2c_f32_bf16 v42, v21, v37
    v_dot2c_f32_bf16 v40, s72, v22
    v_dot2c_f32_bf16 v41, v22, v22
    v_dot2c_f32_bf16 v42, v22, v38
    v_dot2c_f32_bf16 v40, s72, v23
    v_dot2c_f32_bf16 v41, v23, v23
    v_dot2c_f32_bf16 v42, v23, v39
    s_nop 0
    v_add_f32_dpp v40, v40, v40 row_ror:8 row_mask:0xf bank_mask:0xf
    v_add_f32_dpp v41, v41, v41 row_ror:8 row_mask:0xf bank_mask:0xf
    v_add_f32_dpp v42, v42, v42 row_ror:8 row_mask:0xf bank_mask:0xf
    v_add_f32_dpp v40, v40, v40 row_ror:4 row_mask:0xf bank_mask:0xf
    v_add_f32_dpp v41, v41, v41 row_ror:4 row_mask:0xf bank_mask:0xf
    v_add_f32_dpp v42, v42, v42 row_ror:4 row_mask:0xf bank_mask:0xf
    v_add_f32_dpp v40, v40, v40 row_ror:2 row_mask:0xf bank_mask:0xf
    v_add_f32_dpp v41, v41, v41 row_ror:2 row_mask:0xf bank_mask:0xf
    v_add_f32_dpp v42, v42, v42 row_ror:2 row_mask:0xf bank_mask:0xf
    v_add_f32_dpp v40, v40, v40 row_ror:1 row_mask:0xf bank_mask:0xf
    v_add_f32_dpp v41, v41, v41 row_ror:1 row_mask:0xf bank_mask:0xf
    v_add_f32_dpp v42, v42, v42 row_ror:1 row_mask:0xf bank_mask:0xf
    v_mul_f32 v8, s73, v40
    v_mul_f32 v9, s73, v41
    v_fma_f32 v9, -v8, v8, v9
    v_max_f32_e64 v9, 0, v9
    v_cvt_pk_bf16_f32 v9, v9, v9
    v_and_b32 v9, 0xffff0000, v9
    v_add_f32 v9, 0x3727c5ac, v9
    v_cvt_pk_bf16_f32 v9, v9, v9
    v_and_b32 v9, 0xffff0000, v9
    v_sqrt_f32_e64 v9, v9
    s_mov_b32 s73, 0xffff
    v_cvt_pk_bf16_f32 v44, v8, v9
    v_and_b32 v9, 0xffff0000, v44
    v_lshlrev_b32 v8, 16, v44
    v_rcp_f32 v9, v9
    v_fma_f32 v10, -v8, v43, v42
    v_mov_b32 v45, v44
    v_mul_f32 v10, v10, v9
    v_cvt_pk_bf16_f32 v10, v10, v10
    v_permlane16_swap_b32 v44, v45
    v_ashrrev_i32 v11, 31, v10
    v_or_b32 v11, 0x80008000, v11
    v_xor_b32 v10, v10, v11
    v_mov_b32_e64 v11, v10
    s_mov_b32 s70, 0
    s_nop 0
    v_permlane16_swap_b32 v10, v11
    s_mov_b32 exec_lo, 1
    s_mov_b32 exec_hi, 1
    v_bfi_b32 v46, s73, v10, v11
    v_and_b32 v8, 0x7f, v48
    ds_write_b128 v8, v[44:47] offset:256
    s_mov_b64 exec, -1
    v_lshlrev_b32_e64 v8, 4, v1
    s_lshl_b32 s7, s4, 7
    s_add_u32 s7, s7, 4096
    v_add_u32_e64 v9, s7, v8
    s_cmp_lg_u32 s3, 0
    s_waitcnt vmcnt(0) lgkmcnt(0)
    s_barrier
    s_cbranch_scc1 L_pub_done
    s_mov_b64 exec, 0xff
    ds_read_b128 v[12:15], v8 offset:256
    s_waitcnt lgkmcnt(0)
    global_store_dwordx4 v9, v[12:15], s[40:41] sc1
    s_mov_b64 exec, -1
L_pub_done:
    s_barrier
    s_cmp_ge_u32 s5, 28
    s_cbranch_scc1 L_end
    s_barrier
    global_load_dwordx4 v[8:11], v2, s[40:41] offset:-4096 sc1
    global_load_dwordx4 v[12:15], v2, s[40:41] offset:0 sc1
    global_load_dwordx4 v[16:19], v3, s[40:41] offset:-4096 sc1
    global_load_dwordx4 v[20:23], v3, s[40:41] offset:0 sc1
    s_barrier
    s_waitcnt vmcnt(0)
L_aux_cmp:
    v_cmp_ne_u32_e64 vcc, s42, v11
    v_cmp_ne_u32 s[74:75], s42, v15
    v_cmp_ne_u32 s[76:77], s42, v19
    v_cmp_ne_u32 s[78:79], s42, v23
    s_or_b64 s[64:65], vcc, s[74:75]
    s_or_b64 s[64:65], s[64:65], s[78:79]
    s_or_b64 s[64:65], s[64:65], s[76:77]
    s_cbranch_scc1 L_aux_retry
L_aux_ok:
    s_mov_b32 s73, 0xffff0000
    v_lshl_or_b32 v52, v10, 16, v52
    v_and_or_b32 v53, v10, s73, v53
    v_lshl_or_b32 v54, v14, 16, v54
    v_and_or_b32 v55, v14, s73, v55
    v_lshl_or_b32 v56, v18, 16, v56
    v_and_or_b32 v57, v18, s73, v57
    v_lshl_or_b32 v58, v22, 16, v58
    v_and_or_b32 v59, v22, s73, v59
    v_max_u32 v24, v52, v53
    v_min_u32 v25, v52, v53
    v_med3_u32 v25, v24, v25, v54
    v_max_u32_e64 v24, v24, v54
    v_med3_u32 v25, v24, v25, v55
    v_max_u32_e64 v24, v24, v55
    v_med3_u32 v25, v24, v25, v56
    v_max_u32_e64 v24, v24, v56
    v_med3_u32 v25, v24, v25, v57
    v_max_u32_e64 v24, v24, v57
    v_med3_u32 v25, v24, v25, v58
    v_max_u32_e64 v24, v24, v58
    v_med3_u32 v25, v24, v25, v59
    v_max_u32_e64 v24, v24, v59
    ds_write_b64 v163, v[8:9] offset:4096
    ds_write_b64 v163, v[12:13] offset:6144
    ds_write_b64 v163, v[16:17] offset:8192
    ds_write_b64 v163, v[20:21] offset:10240
    v_min_u32_dpp v5, v24, v24 row_ror:8 row_mask:0xf bank_mask:0xf
    v_max_u32_dpp v6, v25, v25 row_ror:8 row_mask:0xf bank_mask:0xf
    v_max_u32_dpp v24, v24, v24 row_ror:8 row_mask:0xf bank_mask:0xf
    v_max_u32 v25, v5, v6
    s_nop 0
    v_min_u32_dpp v5, v24, v24 row_ror:4 row_mask:0xf bank_mask:0xf
    v_max_u32_dpp v6, v25, v25 row_ror:4 row_mask:0xf bank_mask:0xf
    v_max_u32_dpp v24, v24, v24 row_ror:4 row_mask:0xf bank_mask:0xf
    v_max_u32 v25, v5, v6
    s_nop 0
    v_min_u32_dpp v5, v24, v24 row_ror:2 row_mask:0xf bank_mask:0xf
    v_max_u32_dpp v6, v25, v25 row_ror:2 row_mask:0xf bank_mask:0xf
    v_max_u32_dpp v24, v24, v24 row_ror:2 row_mask:0xf bank_mask:0xf
    v_max_u32 v25, v5, v6
    s_nop 0
    v_min_u32_dpp v5, v24, v24 row_ror:1 row_mask:0xf bank_mask:0xf
    v_max_u32_dpp v6, v25, v25 row_ror:1 row_mask:0xf bank_mask:0xf
    v_max_u32_dpp v24, v24, v24 row_ror:1 row_mask:0xf bank_mask:0xf
    v_max_u32_e64 v25, v5, v6
    s_mov_b32 exec_lo, 0x00010001
    s_mov_b32 exec_hi, 0x00010001
    ds_write_b64 v49, v[24:25] offset:0
    s_mov_b64 exec, -1
    s_mov_b32 s74, 0xaaaaaaaa
    s_mov_b32 s75, 0xaaaaaaaa
    s_mov_b32 s70, 0
L_aux_xch:
    ds_read_b64 v[24:25], v60 offset:0
    s_add_u32 s70, s70, 1
    s_waitcnt lgkmcnt(0)
    v_cmp_eq_u32 vcc, 0, v24
    s_cbranch_vccz L_aux_xch_ok
    s_cmp_lt_u32 s70, 8000000
    s_cbranch_scc1 L_aux_xch
L_aux_xch_ok:
    v_min_u32_dpp v5, v24, v24 row_ror:8 row_mask:0xf bank_mask:0xf
    v_max_u32_dpp v6, v25, v25 row_ror:8 row_mask:0xf bank_mask:0xf
    v_max_u32_dpp v24, v24, v24 row_ror:8 row_mask:0xf bank_mask:0xf
    v_max_u32_e64 v25, v5, v6
    s_nop 0
    v_min_u32_dpp v5, v24, v24 row_ror:4 row_mask:0xf bank_mask:0xf
    v_max_u32_dpp v6, v25, v25 row_ror:4 row_mask:0xf bank_mask:0xf
    v_max_u32_dpp v24, v24, v24 row_ror:4 row_mask:0xf bank_mask:0xf
    v_max_u32 v25, v5, v6
    s_nop 0
    v_min_u32_dpp v5, v24, v24 row_ror:2 row_mask:0xf bank_mask:0xf
    v_max_u32_dpp v6, v25, v25 row_ror:2 row_mask:0xf bank_mask:0xf
    v_max_u32_dpp v24, v24, v24 row_ror:2 row_mask:0xf bank_mask:0xf
    v_max_u32 v25, v5, v6
    s_nop 0
    v_min_u32_dpp v5, v24, v24 row_ror:1 row_mask:0xf bank_mask:0xf
    v_max_u32_dpp v6, v25, v25 row_ror:1 row_mask:0xf bank_mask:0xf
    v_max_u32_dpp v24, v24, v24 row_ror:1 row_mask:0xf bank_mask:0xf
    v_max_u32_e64 v25, v5, v6
    v_cndmask_b32 v12, v24, v25, s[74:75]
    v_not_b32_e64 v13, v12
    v_and_b32 v46, 0x7ff, v13
    v_lshl_add_u32 v6, v46, 10, v63
    s_mov_b32 exec_lo, 0x33333333
    s_mov_b32 exec_hi, 0x33333333
    global_load_dwordx4 v[144:147], v6, s[8:9] offset:0
    global_load_dwordx4 v[148:151], v6, s[8:9] offset:64
    global_load_dwordx4 v[152:155], v6, s[8:9] offset:128
    global_load_dwordx4 v[156:159], v6, s[8:9] offset:192
    s_mov_b64 exec, -1
    v_lshlrev_b32 v4, 2, v46
    ds_read_b32 v10, v4 offset:4096
    v_ashrrev_i32_e64 v13, 31, v13
    v_or_b32 v13, 0x80000000, v13
    v_xor_b32_e64 v12, v12, v13
    v_and_b32 v12, 0xffff0000, v12
    v_mul_f32 v12, 0xbfb8aa3b, v12
    v_exp_f32 v12, v12
    s_waitcnt lgkmcnt(0)
    v_and_b32 v16, 0xffff0000, v10
    v_add_f32 v12, 1.0, v12
    v_rcp_f32 v16, v16
    v_rcp_f32 v12, v12
    v_lshlrev_b32 v18, 16, v10
    v_xor_b32 v18, 0x80000000, v18
    v_mul_f32 v14, 0xbfb8aa3b, v16
    v_mul_f32 v12, v12, v16
    v_mul_f32_e64 v12, v12, v14
    s_barrier
    ds_read_b64_tr_b16 v[64:65], v61 offset:0
    ds_read_b64_tr_b16 v[66:67], v61 offset:128
    ds_read_b64_tr_b16 v[80:81], v61 offset:4096
    ds_read_b64_tr_b16 v[82:83], v61 offset:4224
    ds_read_b64_tr_b16 v[68:69], v61 offset:1024
    ds_read_b64_tr_b16 v[70:71], v61 offset:1152
    ds_read_b64_tr_b16 v[84:85], v61 offset:5120
    ds_read_b64_tr_b16 v[86:87], v61 offset:5248
    ds_read_b64_tr_b16 v[72:73], v61 offset:2048
    ds_read_b64_tr_b16 v[74:75], v61 offset:2176
    ds_read_b64_tr_b16 v[88:89], v61 offset:6144
    ds_read_b64_tr_b16 v[90:91], v61 offset:6272
    ds_read_b64_tr_b16 v[76:77], v61 offset:3072
    ds_read_b64_tr_b16 v[78:79], v61 offset:3200
    ds_read_b64_tr_b16 v[92:93], v61 offset:7168
    ds_read_b64_tr_b16 v[94:95], v61 offset:7296
    s_waitcnt vmcnt(3) lgkmcnt(12)
    v_mfma_f32_16x16x32_bf16 v[32:35], v[64:67], v[144:147], 0
    v_mfma_f32_16x16x32_bf16 v[36:39], v[80:83], v[144:147], 0
    s_waitcnt vmcnt(2) lgkmcnt(8)
    v_mfma_f32_16x16x32_bf16 v[32:35], v[68:71], v[148:151], v[32:35]
    v_mfma_f32_16x16x32_bf16 v[36:39], v[84:87], v[148:151], v[36:39]
    s_waitcnt vmcnt(1) lgkmcnt(4)
    v_mfma_f32_16x16x32_bf16 v[32:35], v[72:75], v[152:155], v[32:35]
    v_mfma_f32_16x16x32_bf16 v[36:39], v[88:91], v[152:155], v[36:39]
    s_waitcnt vmcnt(0) lgkmcnt(0)
    v_mfma_f32_16x16x32_bf16 v[32:35], v[76:79], v[156:159], v[32:35]
    v_mfma_f32_16x16x32_bf16 v[36:39], v[92:95], v[156:159], v[36:39]
    s_mov_b32 exec_lo, 0x000f000f
    s_mov_b32 exec_hi, 0x000f000f
    s_nop 4
    ds_write_b128 v160, v[32:35] offset:512
    ds_write_b128 v160, v[36:39] offset:528
    s_mov_b64 exec, -1
    s_waitcnt lgkmcnt(0)
    s_barrier
    ds_read_b128 v[32:35], v161 offset:512
    ds_read_b128 v[36:39], v161 offset:528
    ds_read_b64_tr_b16 v[96:97], v168 offset:8192
    ds_read_b64_tr_b16 v[98:99], v169 offset:8192
    ds_read_b64_tr_b16 v[100:101], v170 offset:8192
    ds_read_b64_tr_b16 v[102:103], v171 offset:8192
    ds_read_b64_tr_b16 v[104:105], v172 offset:8192
    ds_read_b64_tr_b16 v[106:107], v173 offset:8192
    ds_read_b64_tr_b16 v[108:109], v174 offset:8192
    ds_read_b64_tr_b16 v[110:111], v175 offset:8192
    s_waitcnt lgkmcnt(9)
    s_nop 0
    v_add_f32_dpp v32, v32, v32 row_ror:8 row_mask:0xf bank_mask:0xf
    v_add_f32_dpp v33, v33, v33 row_ror:8 row_mask:0xf bank_mask:0xf
    v_add_f32_dpp v34, v34, v34 row_ror:8 row_mask:0xf bank_mask:0xf
    v_add_f32_dpp v35, v35, v35 row_ror:8 row_mask:0xf bank_mask:0xf
    v_add_f32_dpp v32, v32, v32 row_ror:4 row_mask:0xf bank_mask:0xf
    v_add_f32_dpp v33, v33, v33 row_ror:4 row_mask:0xf bank_mask:0xf
    v_add_f32_dpp v34, v34, v34 row_ror:4 row_mask:0xf bank_mask:0xf
    v_add_f32_dpp v35, v35, v35 row_ror:4 row_mask:0xf bank_mask:0xf
    v_fmac_f32_dpp v32, v32, v18 quad_perm:[2,3,2,3] row_mask:0xf bank_mask:0xf
    v_fmac_f32_dpp v33, v33, v18 quad_perm:[2,3,2,3] row_mask:0xf bank_mask:0xf
    v_fmac_f32_dpp v34, v34, v18 quad_perm:[2,3,2,3] row_mask:0xf bank_mask:0xf
    v_fmac_f32_dpp v35, v35, v18 quad_perm:[2,3,2,3] row_mask:0xf bank_mask:0xf
    v_pk_mul_f32 v[28:29], v[32:33], v[14:15] op_sel_hi:[1,0]
    v_pk_mul_f32 v[30:31], v[34:35], v[14:15] op_sel_hi:[1,0]
    s_waitcnt lgkmcnt(8)
    v_exp_f32 v28, v28
    v_exp_f32 v29, v29
    v_exp_f32 v30, v30
    v_exp_f32_e64 v31, v31
    v_add_f32_dpp v36, v36, v36 row_ror:8 row_mask:0xf bank_mask:0xf
    v_add_f32_dpp v37, v37, v37 row_ror:8 row_mask:0xf bank_mask:0xf
    v_add_f32_dpp v38, v38, v38 row_ror:8 row_mask:0xf bank_mask:0xf
    v_add_f32_dpp v39, v39, v39 row_ror:8 row_mask:0xf bank_mask:0xf
    v_add_f32_dpp v36, v36, v36 row_ror:4 row_mask:0xf bank_mask:0xf
    v_add_f32_dpp v37, v37, v37 row_ror:4 row_mask:0xf bank_mask:0xf
    v_add_f32_dpp v38, v38, v38 row_ror:4 row_mask:0xf bank_mask:0xf
    v_add_f32_dpp v39, v39, v39 row_ror:4 row_mask:0xf bank_mask:0xf
    v_fmac_f32_dpp v36, v36, v18 quad_perm:[2,3,2,3] row_mask:0xf bank_mask:0xf
    v_fmac_f32_dpp v37, v37, v18 quad_perm:[2,3,2,3] row_mask:0xf bank_mask:0xf
    v_fmac_f32_dpp v38, v38, v18 quad_perm:[2,3,2,3] row_mask:0xf bank_mask:0xf
    v_fmac_f32_dpp v39, v39, v18 quad_perm:[2,3,2,3] row_mask:0xf bank_mask:0xf
    v_pk_add_f32 v[28:29], v[28:29], 1.0 op_sel_hi:[1,0]
    v_pk_add_f32 v[30:31], v[30:31], 1.0 op_sel_hi:[1,0]
    v_rcp_f32 v28, v28
    v_rcp_f32 v29, v29
    v_rcp_f32 v30, v30
    v_rcp_f32 v31, v31
    v_pk_mul_f32 v[32:33], v[32:33], v[12:13] op_sel_hi:[1,0]
    v_pk_mul_f32 v[34:35], v[34:35], v[12:13] op_sel_hi:[1,0]
    v_pk_mul_f32 v[32:33], v[32:33], v[36:37]
    v_pk_mul_f32 v[34:35], v[34:35], v[38:39]
    v_pk_mul_f32 v[32:33], v[32:33], v[28:29]
    v_pk_mul_f32 v[34:35], v[34:35], v[30:31]
    v_cvt_pk_bf16_f32 v8, v32, v33
    v_cvt_pk_bf16_f32 v9, v34, v35
    s_nop 0
    s_nop 0
    v_and_b32_dpp v144, v8, v136 quad_perm:[0,1,0,1] row_mask:0xf bank_mask:0xf
    v_and_b32_dpp v145, v9, v136 quad_perm:[0,1,0,1] row_mask:0xf bank_mask:0xf
    v_and_b32_dpp v146, v8, v137 quad_perm:[0,1,0,1] row_mask:0xf bank_mask:0xf
    v_and_b32_dpp v147, v9, v137 quad_perm:[0,1,0,1] row_mask:0xf bank_mask:0xf
    v_and_b32_dpp v148, v8, v138 quad_perm:[0,1,0,1] row_mask:0xf bank_mask:0xf
    v_and_b32_dpp v149, v9, v138 quad_perm:[0,1,0,1] row_mask:0xf bank_mask:0xf
    v_and_b32_dpp v150, v8, v139 quad_perm:[0,1,0,1] row_mask:0xf bank_mask:0xf
    v_and_b32_dpp v151, v9, v139 quad_perm:[0,1,0,1] row_mask:0xf bank_mask:0xf
    s_waitcnt lgkmcnt(0)
    v_mfma_f32_16x16x32_bf16 v[32:35], v[96:99], v[144:147], 0
    v_and_b32_dpp v152, v8, v140 quad_perm:[0,1,0,1] row_mask:0xf bank_mask:0xf
    v_and_b32_dpp v153, v9, v140 quad_perm:[0,1,0,1] row_mask:0xf bank_mask:0xf
    v_and_b32_dpp v154, v8, v141 quad_perm:[0,1,0,1] row_mask:0xf bank_mask:0xf
    v_and_b32_dpp v155, v9, v141 quad_perm:[0,1,0,1] row_mask:0xf bank_mask:0xf
    v_mfma_f32_16x16x32_bf16 v[32:35], v[100:103], v[148:151], v[32:35]
    v_and_b32_dpp v156, v8, v142 quad_perm:[0,1,0,1] row_mask:0xf bank_mask:0xf
    v_and_b32_dpp v157, v9, v142 quad_perm:[0,1,0,1] row_mask:0xf bank_mask:0xf
    v_and_b32_dpp v158, v8, v143 quad_perm:[0,1,0,1] row_mask:0xf bank_mask:0xf
    v_and_b32_dpp v159, v9, v143 quad_perm:[0,1,0,1] row_mask:0xf bank_mask:0xf
    v_mfma_f32_16x16x32_bf16 v[32:35], v[104:107], v[152:155], v[32:35]
    s_nop 0
    v_mfma_f32_16x16x32_bf16 v[32:35], v[108:111], v[156:159], v[32:35]
    s_nop 7
    v_cvt_pk_bf16_f32 v44, v32, v33
    v_cvt_pk_bf16_f32 v45, v34, v35
    global_store_dwordx4 v162, v[44:47], s[40:41] sc1
    s_or_b32 s7, s43, s3
    s_cbranch_scc1 L_aux_done
    s_mov_b64 exec, 1
    v_mov_b32_e64 v2, 0
    global_store_dword v2, v47, s[38:39] sc0 sc1
    s_waitcnt vmcnt(0)
    global_store_dword v2, v47, s[40:41] sc0 sc1
L_aux_done:
    s_endpgm
L_aux_retry:
    s_add_u32 s70, s70, 1
    s_cmp_ge_u32 s70, 1000000
    s_cbranch_scc1 L_aux_ok
    s_sleep 1
    s_mov_b64 exec, vcc
    s_cbranch_execz L_aux_s0
    global_load_dwordx4 v[8:11], v2, s[40:41] offset:-4096 sc1
L_aux_s0:
    s_mov_b64 exec, s[74:75]
    s_cbranch_execz L_aux_s1
    global_load_dwordx4 v[12:15], v2, s[40:41] offset:0 sc1
L_aux_s1:
    s_mov_b64 exec, s[76:77]
    s_cbranch_execz L_aux_s2
    global_load_dwordx4 v[16:19], v3, s[40:41] offset:-4096 sc1
L_aux_s2:
    s_mov_b64 exec, s[78:79]
    s_cbranch_execz L_aux_s3
    global_load_dwordx4 v[20:23], v3, s[40:41] offset:0 sc1
L_aux_s3:
    s_mov_b64 exec, -1
    s_waitcnt vmcnt(0)
    s_branch L_aux_cmp
L_aux_loader:
    s_lshr_b32 s43, s6, 1
    s_mul_i32 s43, s43, 28
    s_and_b32 s7, s6, 1
    s_lshl_b32 s7, s7, 4
    s_add_u32 s7, s7, s5
    s_add_u32 s43, s43, s7
    s_cmp_ge_u32 s7, 28
    s_cbranch_scc1 L_end
    s_and_b32 s71, s3, 3
    s_and_b32 s7, s43, 2
    s_lshl_b32 s72, s7, 5
    v_lshrrev_b32 v4, 1, v1
    s_lshl_b32 s73, s71, 7
    s_xor_b32 s73, s73, s72
    v_add_u32 v4, s73, v4
    v_xor_b32 v5, 64, v4
    v_mul_u32_u24 v4, 3584, v4
    v_mul_u32_u24 v5, 3584, v5
    v_and_b32 v6, 1, v1
    v_lshlrev_b32_e64 v6, 4, v6
    s_lshl_b32 s73, s43, 5
    v_add3_u32 v8, v4, v6, s73
    v_add3_u32 v10, v5, v6, s73
    v_add_u32 v9, 114688, v8
    v_add_u32 v11, 114688, v10
    v_lshrrev_b32 v4, 4, v1
    v_and_b32 v5, 15, v1
    v_lshlrev_b32 v6, 1, v4
    v_xor_b32 v5, v5, v6
    v_lshlrev_b32_e64 v5, 4, v5
    v_lshl_add_u32 v4, v4, 10, v5
    s_lshl_b32 s73, s43, 14
    s_lshl_b32 s74, s71, 8
    s_add_u32 s73, s73, s74
    v_add_u32 v12, s73, v4
    v_xor_b32 v13, 0x1080, v12
    v_add_u32 v14, 8192, v12
    v_add_u32 v15, 8192, v13
    s_mul_i32 s73, s71, 12288
    s_add_u32 s73, s73, 16384
    s_and_b32 s7, s43, 1
    s_lshl_b32 s7, s7, 12
    s_lshl_b32 s72, s72, 5
    s_or_b32 s72, s72, s7
    s_waitcnt lgkmcnt(0)
    s_bitcmp1_b32 s43, 0
    s_cselect_b32 s44, s32, s30
    s_cselect_b32 s45, s33, s31
    s_cselect_b32 s46, s30, s32
    s_cselect_b32 s47, s31, s33
    s_barrier
    s_barrier
    s_xor_b32 s7, s72, 0
    s_add_u32 m0, s7, s73
    s_nop 0
    global_load_lds_dwordx4 v8, s[44:45]
    s_add_u32 m0, m0, 1024
    s_nop 0
    global_load_lds_dwordx4 v9, s[44:45]
    s_add_u32 m0, s73, 8192
    s_nop 0
    global_load_lds_dwordx4 v12, s[34:35]
    s_add_u32 m0, s73, 9216
    s_nop 0
    global_load_lds_dwordx4 v13, s[34:35]
    s_add_u32 m0, s73, 10240
    s_nop 0
    global_load_lds_dwordx4 v14, s[34:35]
    s_add_u32 m0, s73, 11264
    s_nop 0
    global_load_lds_dwordx4 v15, s[34:35]
    s_waitcnt vmcnt(4)
    s_xor_b32 s7, s72, 4096
    s_add_u32 m0, s7, s73
    s_nop 0
    global_load_lds_dwordx4 v8, s[46:47]
    s_add_u32 m0, m0, 1024
    s_nop 0
    global_load_lds_dwordx4 v9, s[46:47]
    s_waitcnt vmcnt(2)
    s_barrier
    s_barrier
    s_xor_b32 s7, s72, 2048
    s_add_u32 m0, s7, s73
    s_nop 0
    global_load_lds_dwordx4 v10, s[44:45]
    s_add_u32 m0, m0, 1024
    s_nop 0
    global_load_lds_dwordx4 v11, s[44:45]
    s_waitcnt vmcnt(1)
    s_xor_b32 s7, s72, 6144
    s_add_u32 m0, s7, s73
    s_nop 0
    global_load_lds_dwordx4 v10, s[46:47]
    s_add_u32 m0, m0, 1024
    s_nop 0
    global_load_lds_dwordx4 v11, s[46:47]
    s_waitcnt vmcnt(0)
    s_endpgm
L_end:
    s_endpgm
L_code_end:
.section .rodata,"a"
.p2align 6
.amdhsa_kernel recurrent_scan__ssm_conv_s4__moe_arch_mod__prompt_kernel
  .amdhsa_next_free_vgpr 256
  .amdhsa_next_free_sgpr 102
  .amdhsa_accum_offset 256
  .amdhsa_group_segment_fixed_size 0
  .amdhsa_kernarg_size 136
  .amdhsa_user_sgpr_count 2
  .amdhsa_user_sgpr_kernarg_segment_ptr 1
  .amdhsa_system_sgpr_workgroup_id_x 1
.end_amdhsa_kernel
```
